```python
import torch

def _softmax(x, axis=-1):
    return torch.softmax(x, dim=axis)
def _gelu(x):
    return torch.nn.functional.gelu(x, approximate="tanh")
def _silu(x):
    return torch.nn.functional.silu(x)
def _sigmoid(x):
    return torch.sigmoid(x)
def _layernorm(x, axis=-1, eps=1e-5):
    m = x.mean(dim=axis, keepdim=True)
    v = x.var(dim=axis, keepdim=True, unbiased=False)
    return (x - m) / torch.sqrt(v + eps)
def _scatter_add(tgt, idx, src, axis=0):
    return tgt.clone().index_add_(axis, idx, src)
def _segment_sum(src, seg, n):
    out = torch.zeros((n,) + src.shape[1:], dtype=src.dtype)
    return out.index_add_(0, seg, src)
def _pad(x, pw):
    flat = tuple(v for pair in reversed(pw) for v in pair)
    return torch.nn.functional.pad(x, flat)

kernel_name = 'standalone__linear_kernel_hedgehog__prompt'

def setup_inputs():

    _w = (lambda a: (lambda t: t.to(torch.bfloat16) if t.is_floating_point() else t)(torch.as_tensor(a)))
    B, S, D, H = 1, 2048, 1024, 32
    Dh = D // H
    return {
        "x": _w((lambda *s: torch.randn(*s, dtype=torch.bfloat16) * 0.4)(B, S, D)),
        "wqkv": _w((lambda *s: torch.randn(*s, dtype=torch.bfloat16) * 0.4)(D, 3 * D)),
        "w_phi": _w((lambda *s: torch.randn(*s, dtype=torch.bfloat16) * 0.4)(H, Dh, Dh) * (Dh ** -0.5)),
        "wo": _w((lambda *s: torch.randn(*s, dtype=torch.bfloat16) * 0.05)(D, D)),
    }

def reference(x, wqkv, w_phi, wo):
    B, S, D = x.shape
    H = 32; Dh = D // H
    qkv = (lambda x, *d: x.permute(*d))((x @ wqkv).reshape(B, S, 3, H, Dh), 2, 0, 3, 1, 4)
    q, k, v = qkv[0], qkv[1], qkv[2]
    pq = torch.einsum("bhsd,hdf->bhsf", q, w_phi)
    pk = torch.einsum("bhsd,hdf->bhsf", k, w_phi)
    phi_q = torch.concatenate([_softmax(pq, axis=-1), _softmax(-pq, axis=-1)], axis=-1)
    phi_k = torch.concatenate([_softmax(pk, axis=-1), _softmax(-pk, axis=-1)], axis=-1)
    kv = torch.einsum("bhsf,bhsd->bhfd", phi_k, v)
    z  = torch.einsum("bhsf->bhf", phi_k)
    num = torch.einsum("bhqf,bhfd->bhqd", phi_q, kv)
    den = torch.einsum("bhqf,bhf->bhq", phi_q, z)[..., None] + 1e-6
    o = num / den
    return (lambda x, *d: x.permute(*d))(o, 0, 2, 1, 3).reshape(B, S, D) @ wo
```

```asm
; @launch grid=(256,1,1) block=(512,1,1) lds=163840
.amdgcn_target "amdgcn-amd-amdhsa--gfx950"
.text
.globl standalone__linear_kernel_hedgehog__prompt_kernel
.p2align 8
.type standalone__linear_kernel_hedgehog__prompt_kernel,@function
standalone__linear_kernel_hedgehog__prompt_kernel:
    s_load_dwordx8 s[4:11], s[0:1], 0
    s_load_dwordx4 s[12:15], s[0:1], 32
    s_load_dwordx2 s[16:17], s[0:1], 48
    s_cmp_ge_u32 s2, 256
    s_cbranch_scc1 L_end
    v_lshrrev_b32 v26, 6, v0
    v_and_b32 v1, 63, v0
    v_readfirstlane_b32 s3, v26
    s_and_b32 s52, s2, 7
    s_bfe_u32 s48, s2, 0x40003
    s_lshr_b32 s49, s2, 7
    s_lshl1_add_u32 s49, s52, s49
    s_bfe_u32 s50, s2, 0x10003
    s_lshl1_add_u32 s50, s52, s50
    s_lshr_b32 s53, 0x5959, s49
    s_and_b32 s53, s53, 1
    s_bfe_u32 s54, s2, 0x10006
    s_lshl1_add_u32 s53, s54, s53
    s_bfe_u32 s51, s2, 0x20004
    s_lshl2_add_u32 s51, s53, s51
    s_and_b32 s62, s3, 3
    s_cmp_ge_u32 s3, 4
    s_cbranch_scc1 L_cwave
    v_lshrrev_b32 v26, 3, v1
    v_lshrrev_b32 v27, 4, v1
    v_and_b32 v28, 7, v1
    v_xor_b32 v29, v28, v27
    v_lshlrev_b32 v29, 4, v29
    s_lshl2_add_u32 s52, s48, s62
    s_lshl_b32 s52, s52, 16
    v_lshl_add_u32 v30, v26, 11, v29
    v_add_u32 v2, s52, v30
    v_xor_b32 v3, 64, v2
    v_add_u32 v3, 0x3c00, v3
    v_add_u32 v4, 0x7800, v2
    v_add_u32 v5, 0x7800, v3
    v_and_b32 v27, 1, v27
    v_lshlrev_b32 v27, 1, v27
    v_xor_b32 v29, v28, v27
    v_lshlrev_b32 v29, 4, v29
    v_mul_u32_u24 v30, 0x1800, v26
    s_mul_i32 s52, s62, 98304
    s_lshl_b32 s53, s49, 7
    s_add_u32 s52, s52, s53
    v_add3_u32 v8, s52, v30, v29
    v_xor_b32 v9, 64, v8
    v_add_u32 v9, 0xbc00, v9
    v_add_u32 v6, 0x800, v8
    v_add_u32 v7, 0x800, v9
    s_lshl_b32 s58, s62, 12
    s_lshl_b32 s63, s62, 11
    s_mul_i32 s64, s48, 2
    s_bitcmp1_b32 s49, 0
    s_mov_b32 s94, 0x47651320
    s_cselect_b32 s94, 0x76543210, s94
    s_mov_b32 s65, 0x65473102
    s_cselect_b32 s65, 0x54761032, s65
    s_bitcmp1_b32 s49, 1
    s_cselect_b32 s94, s65, s94
    s_bfe_u32 s56, s94, 0x40000
    s_add_u32 s56, s56, s64
    s_and_b32 s56, s56, 15
    s_mul_i32 s57, s56, 393216
    s_lshl_b32 s56, s56, 7
    v_lshlrev_b32 v10, 4, v1
    s_lshl2_add_u32 s54, s49, s62
    s_lshl_b32 s96, s54, 10
    s_lshl_b32 s97, s62, 10
    s_add_u32 s97, s97, 0x26000
    s_mov_b32 m0, s58
    s_waitcnt lgkmcnt(0)
    s_mov_b32 s20, s4
    s_and_b32 s21, s5, 0xffff
    s_mov_b32 s22, 0x400000
    s_mov_b32 s23, 0x20000
    s_mov_b32 s24, s6
    s_and_b32 s25, s7, 0xffff
    s_mov_b32 s26, 0x600000
    s_mov_b32 s27, 0x20000
    buffer_load_dwordx4 v2, s[20:23], s56 offen offset:0  lds
    buffer_load_dwordx4 v3, s[20:23], s56 offen offset:1024  lds
    buffer_load_dwordx4 v4, s[20:23], s56 offen offset:2048  lds
    buffer_load_dwordx4 v5, s[20:23], s56 offen offset:3072  lds
    s_add_u32 m0, s58, 0x4000
    s_nop 0
    buffer_load_dwordx4 v6, s[24:27], s57 offen offset:0  lds
    buffer_load_dwordx4 v7, s[24:27], s57 offen offset:1024  lds
    buffer_load_dwordx4 v6, s[24:27], s57 offen offset:2048  lds
    buffer_load_dwordx4 v7, s[24:27], s57 offen offset:3072  lds
    s_add_u32 m0, s63, 0x8000
    s_nop 0
    buffer_load_dwordx4 v8, s[24:27], s57 offen offset:0  lds
    buffer_load_dwordx4 v9, s[24:27], s57 offen offset:1024  lds
    s_bfe_u32 s56, s94, 0x40004
    s_add_u32 s56, s56, s64
    s_and_b32 s56, s56, 15
    s_mul_i32 s57, s56, 393216
    s_lshl_b32 s56, s56, 7
    s_mov_b32 s28, s8
    s_and_b32 s29, s9, 0xffff
    s_mov_b32 s30, 0x10000
    s_mov_b32 s31, 0x20000
    s_mov_b32 m0, s97
    s_nop 0
    buffer_load_dwordx4 v10, s[28:31], s96 offen lds
    s_add_u32 m0, s58, 0xa000
    s_nop 0
    buffer_load_dwordx4 v2, s[20:23], s56 offen offset:0  lds
    buffer_load_dwordx4 v3, s[20:23], s56 offen offset:1024  lds
    buffer_load_dwordx4 v4, s[20:23], s56 offen offset:2048  lds
    buffer_load_dwordx4 v5, s[20:23], s56 offen offset:3072  lds
    s_add_u32 m0, s58, 0xe000
    s_nop 0
    buffer_load_dwordx4 v6, s[24:27], s57 offen offset:0  lds
    buffer_load_dwordx4 v7, s[24:27], s57 offen offset:1024  lds
    buffer_load_dwordx4 v6, s[24:27], s57 offen offset:2048  lds
    buffer_load_dwordx4 v7, s[24:27], s57 offen offset:3072  lds
    s_add_u32 m0, s63, 0x12000
    s_nop 0
    buffer_load_dwordx4 v8, s[24:27], s57 offen offset:0  lds
    buffer_load_dwordx4 v9, s[24:27], s57 offen offset:1024  lds
    s_bitcmp1_b32 s49, 0
    s_mov_b32 s95, 0xcfed8ba9
    s_cselect_b32 s95, 0xfedcba98, s95
    s_mov_b32 s65, 0xedcfa98b
    s_cselect_b32 s65, 0xdcfe98ba, s65
    s_bitcmp1_b32 s49, 1
    s_cselect_b32 s95, s65, s95
    s_bfe_u32 s56, s94, 0x40008
    s_add_u32 s56, s56, s64
    s_and_b32 s56, s56, 15
    s_mul_i32 s57, s56, 393216
    s_lshl_b32 s56, s56, 7
    s_mov_b32 s32, s10
    s_and_b32 s33, s11, 0xffff
    s_mov_b32 s34, 0x200000
    s_mov_b32 s35, 0x20000
    s_mov_b32 s40, s16
    s_and_b32 s41, s17, 0xffff
    s_mov_b32 s42, 0x10000000
    s_mov_b32 s43, 0x20000
    s_mov_b32 s44, s14
    s_and_b32 s45, s15, 0xffff
    s_mov_b32 s46, 0x100
    s_mov_b32 s47, 0x20000
    s_mov_b32 s36, s12
    s_and_b32 s37, s13, 0xffff
    s_mov_b32 s38, 0x400000
    s_mov_b32 s39, 0x20000
    v_lshl_add_u32 v16, v26, 11, v29
    s_lshl2_add_u32 s66, s49, s62
    s_lshl_b32 s66, s66, 6
    s_add_u32 s66, s66, s48
    s_lshl_b32 s66, s66, 10
    s_lshl2_add_u32 s67, s48, s62
    s_lshl_b32 s67, s67, 5
    s_add_u32 s67, s67, s49
    s_lshl_b32 s67, s67, 11
    s_add_u32 s67, s67, 0x400000
    s_lshl2_add_u32 s68, s49, s62
    s_lshl4_add_u32 s68, s68, s48
    s_lshl_b32 s68, s68, 7
    s_add_u32 s68, s68, 0x800000
    s_lshl4_add_u32 s69, s49, s48
    s_lshl2_add_u32 s69, s69, s62
    s_lshl_b32 s69, s69, 7
    s_add_u32 s69, s69, 0x820000
    v_mov_b32 v12, -1
    v_mov_b32 v13, -1
    v_mov_b32 v14, -1
    v_mov_b32 v15, -1
    s_sub_u32 s52, s69, s68
    v_bfe_u32 v11, v1, 3, 1
    v_mul_lo_u32 v11, v11, s52
    v_lshl_add_u32 v11, v28, 4, v11
    s_getreg_b32 s70, hwreg(HW_REG_XCC_ID)
    s_and_b32 s70, s70, 7
    s_add_u32 s80, s12, s66
    s_addc_u32 s81, s13, 0
    s_add_u32 s82, s16, s68
    s_addc_u32 s83, s17, 0
    s_add_u32 s84, s16, s69
    s_addc_u32 s85, s17, 0
    s_lshl4_add_u32 s52, s49, s48
    s_lshl_b32 s52, s52, 7
    s_add_u32 s52, s52, 0x840000
    s_add_u32 s86, s16, s52
    s_addc_u32 s87, s17, 0
    s_lshl_b32 s52, s51, 7
    v_add_u32 v128, s52, v16
    v_xor_b32 v129, 64, v128
    v_add_u32 v129, 0x3c00, v129
    v_add_u32 v130, 0x7800, v128
    v_add_u32 v131, 0x7800, v129
    s_lshl_b32 s52, s49, 11
    s_add_u32 s52, s52, 0x840000
    v_and_b32 v132, 31, v1
    s_andn2_b32 s53, s52, 0x800
    v_lshl_add_u32 v132, v132, 7, s53
    s_lshl_b32 s78, s48, 7
    s_lshl2_add_u32 s78, s62, s78
    s_add_u32 s78, s78, s52
    v_lshrrev_b32 v26, 4, v1
    v_bfe_u32 v27, v1, 2, 2
    v_lshl_add_u32 v27, v26, 2, v27
    v_bfe_u32 v28, v27, 1, 2
    v_bfe_u32 v29, v1, 1, 1
    v_xor_b32 v28, v28, v29
    v_lshlrev_b32 v28, 4, v28
    v_lshl_add_u32 v28, v27, 6, v28
    v_and_b32 v29, 1, v1
    v_lshl_add_u32 v28, v29, 3, v28
    s_add_u32 s72, s58, 0x1c000
    v_add_u32 v18, s72, v28
    v_xor_b32 v19, 32, v18
    s_add_u32 s72, s58, 0x20000
    s_lshr_b32 s52, s62, 1
    s_lshl_b32 s52, s52, 13
    s_add_u32 s52, s52, 0x24000
    v_add_u32 v20, s52, v28
    v_xor_b32 v21, 32, v20
    v_mov_b32 v32, 0x3f803f80
    v_mov_b32 v33, 0x3f803f80
    v_mov_b32 v34, 0x3f803f80
    v_mov_b32 v35, 0x3f803f80
    v_and_b32 v27, 15, v1
    v_lshlrev_b32 v22, 4, v27
    v_lshl_add_u32 v22, v26, 10, v22
    s_lshl4_add_u32 s73, s49, s48
    s_lshl_b32 s73, s73, 6
    s_add_u32 s73, s73, s62
    s_lshl_b32 s73, s73, 8
    v_add_u32 v22, s73, v22
    v_lshrrev_b32 v28, 5, v1
    v_lshlrev_b32 v28, 2, v28
    v_lshl_add_u32 v24, v27, 3, v28
    v_and_b32 v29, 7, v1
    v_lshl_add_u32 v25, v29, 3, v28
    v_add_u32 v25, s72, v25
    v_add_u32 v17, s72, v10
    v_add_u32 v142, s58, v10
    v_add_u32 v143, 0x10000, v142
    v_bfe_u32 v28, v1, 2, 1
    v_lshlrev_b32 v23, 10, v28
    v_lshl_add_u32 v23, v26, 8, v23
    v_bfe_u32 v28, v1, 3, 1
    v_lshl_add_u32 v23, v28, 5, v23
    v_and_b32 v28, 3, v1
    v_lshl_add_u32 v23, v28, 3, v23
    s_lshl2_add_u32 s74, s49, s62
    s_lshl_b32 s74, s74, 11
    s_add_u32 s75, s74, 0x800000
    s_add_u32 s74, s74, 0x820000
    v_lshlrev_b32 v136, 2, v1
    v_lshlrev_b32 v26, 4, v1
    s_lshl2_add_u32 s52, s50, s62
    s_lshl_b32 s52, s52, 16
    s_lshl_b32 s79, s51, 7
    s_add_u32 s79, s79, s52
    s_add_u32 s52, s52, 0x400000
    v_add_u32 v240, s52, v26
    v_xor_b32 v241, 0x8000, v240
    s_lshl_b32 s52, s3, 12
    s_add_u32 s52, s52, 0x20000
    v_add_u32 v138, s52, v26
    v_xor_b32 v139, 0x4000, v138
    v_lshrrev_b32 v26, 4, v1
    v_bfe_u32 v27, v1, 2, 2
    v_lshl_add_u32 v27, v26, 3, v27
    v_lshlrev_b32 v27, 7, v27
    v_bfe_u32 v28, v1, 3, 2
    v_lshl_add_u32 v27, v28, 5, v27
    v_and_b32 v28, 3, v1
    v_lshl_add_u32 v242, v28, 3, v27
    v_xor_b32 v243, 32, v242
    v_xor_b32 v244, 64, v242
    v_xor_b32 v245, 96, v242
    v_and_b32 v27, 15, v1
    v_lshlrev_b32 v27, 11, v27
    v_and_b32 v28, 1, v26
    v_lshl_add_u32 v27, v28, 5, v27
    v_lshrrev_b32 v28, 1, v26
    v_lshl_add_u32 v140, v28, 4, v27
    s_lshl2_add_u32 s52, s50, s62
    s_lshl_b32 s52, s52, 9
    s_add_u32 s52, s52, 0x850000
    s_or_b32 s53, s49, 1
    s_lshl1_add_u32 s53, s53, 2
    v_add_u32 v27, s53, v1
    v_and_b32 v27, 15, v27
    v_lshl_add_u32 v27, v27, 2, v26
    v_lshl_add_u32 v141, v27, 2, s52
    s_lshl1_add_u32 s71, s50, s62
    s_waitcnt vmcnt(10)
    s_barrier
    s_add_u32 m0, s58, 0x14000
    s_nop 0
    buffer_load_dwordx4 v2, s[20:23], s56 offen offset:0  lds
    buffer_load_dwordx4 v3, s[20:23], s56 offen offset:1024  lds
    buffer_load_dwordx4 v4, s[20:23], s56 offen offset:2048  lds
    buffer_load_dwordx4 v5, s[20:23], s56 offen offset:3072  lds
    s_add_u32 m0, s58, 0x18000
    s_nop 0
    buffer_load_dwordx4 v6, s[24:27], s57 offen offset:0  lds
    buffer_load_dwordx4 v7, s[24:27], s57 offen offset:1024  lds
    buffer_load_dwordx4 v6, s[24:27], s57 offen offset:2048  lds
    buffer_load_dwordx4 v7, s[24:27], s57 offen offset:3072  lds
    s_add_u32 m0, s63, 0x1c000
    s_nop 0
    buffer_load_dwordx4 v8, s[24:27], s57 offen offset:0  lds
    buffer_load_dwordx4 v9, s[24:27], s57 offen offset:1024  lds
    s_bfe_u32 s56, s94, 0x4000c
    s_add_u32 s56, s56, s64
    s_and_b32 s56, s56, 15
    s_mul_i32 s57, s56, 393216
    s_lshl_b32 s56, s56, 7
    s_load_dwordx2 s[90:91], s[86:87], 0x0
    s_load_dwordx2 s[90:91], s[80:81], 0x3c
    s_load_dwordx2 s[90:91], s[80:81], 0xbc
    s_waitcnt vmcnt(10)
    s_barrier
    s_add_u32 m0, s58, 0x1e000
    s_nop 0
    buffer_load_dwordx4 v2, s[20:23], s56 offen offset:0  lds
    buffer_load_dwordx4 v3, s[20:23], s56 offen offset:1024  lds
    buffer_load_dwordx4 v4, s[20:23], s56 offen offset:2048  lds
    buffer_load_dwordx4 v5, s[20:23], s56 offen offset:3072  lds
    s_add_u32 m0, s58, 0x22000
    s_nop 0
    buffer_load_dwordx4 v6, s[24:27], s57 offen offset:0  lds
    buffer_load_dwordx4 v7, s[24:27], s57 offen offset:1024  lds
    buffer_load_dwordx4 v6, s[24:27], s57 offen offset:2048  lds
    buffer_load_dwordx4 v7, s[24:27], s57 offen offset:3072  lds
    s_add_u32 m0, s63, 0x26000
    s_nop 0
    buffer_load_dwordx4 v8, s[24:27], s57 offen offset:0  lds
    buffer_load_dwordx4 v9, s[24:27], s57 offen offset:1024  lds
    s_bfe_u32 s56, s94, 0x40010
    s_add_u32 s56, s56, s64
    s_and_b32 s56, s56, 15
    s_mul_i32 s57, s56, 393216
    s_lshl_b32 s56, s56, 7
    s_add_u32 m0, s58, 0x0
    s_nop 0
    buffer_load_dwordx4 v2, s[20:23], s56 offen offset:0  lds
    buffer_load_dwordx4 v3, s[20:23], s56 offen offset:1024  lds
    buffer_load_dwordx4 v4, s[20:23], s56 offen offset:2048  lds
    buffer_load_dwordx4 v5, s[20:23], s56 offen offset:3072  lds
    s_add_u32 m0, s58, 0x4000
    s_nop 0
    buffer_load_dwordx4 v6, s[24:27], s57 offen offset:0  lds
    buffer_load_dwordx4 v7, s[24:27], s57 offen offset:1024  lds
    buffer_load_dwordx4 v6, s[24:27], s57 offen offset:2048  lds
    buffer_load_dwordx4 v7, s[24:27], s57 offen offset:3072  lds
    s_add_u32 m0, s63, 0x8000
    s_nop 0
    buffer_load_dwordx4 v8, s[24:27], s57 offen offset:0  lds
    buffer_load_dwordx4 v9, s[24:27], s57 offen offset:1024  lds
    s_bfe_u32 s56, s94, 0x40014
    s_add_u32 s56, s56, s64
    s_and_b32 s56, s56, 15
    s_mul_i32 s57, s56, 393216
    s_lshl_b32 s56, s56, 7
    s_load_dwordx2 s[90:91], s[80:81], 0x13c
    s_load_dwordx2 s[90:91], s[80:81], 0x1bc
    s_load_dwordx2 s[90:91], s[80:81], 0x23c
    s_waitcnt vmcnt(20)
    s_barrier
    s_add_u32 m0, s58, 0xa000
    s_nop 0
    buffer_load_dwordx4 v2, s[20:23], s56 offen offset:0  lds
    buffer_load_dwordx4 v3, s[20:23], s56 offen offset:1024  lds
    buffer_load_dwordx4 v4, s[20:23], s56 offen offset:2048  lds
    buffer_load_dwordx4 v5, s[20:23], s56 offen offset:3072  lds
    s_add_u32 m0, s58, 0xe000
    s_nop 0
    buffer_load_dwordx4 v6, s[24:27], s57 offen offset:0  lds
    buffer_load_dwordx4 v7, s[24:27], s57 offen offset:1024  lds
    buffer_load_dwordx4 v6, s[24:27], s57 offen offset:2048  lds
    buffer_load_dwordx4 v7, s[24:27], s57 offen offset:3072  lds
    s_add_u32 m0, s63, 0x12000
    s_nop 0
    buffer_load_dwordx4 v8, s[24:27], s57 offen offset:0  lds
    buffer_load_dwordx4 v9, s[24:27], s57 offen offset:1024  lds
    s_bfe_u32 s56, s94, 0x40018
    s_add_u32 s56, s56, s64
    s_and_b32 s56, s56, 15
    s_mul_i32 s57, s56, 393216
    s_lshl_b32 s56, s56, 7
    s_load_dwordx2 s[90:91], s[80:81], 0x2bc
    s_load_dwordx2 s[90:91], s[80:81], 0x33c
    s_load_dwordx2 s[90:91], s[80:81], 0x3bc
    s_waitcnt vmcnt(20)
    s_barrier
    s_add_u32 m0, s58, 0x14000
    s_nop 0
    buffer_load_dwordx4 v2, s[20:23], s56 offen offset:0  lds
    buffer_load_dwordx4 v3, s[20:23], s56 offen offset:1024  lds
    buffer_load_dwordx4 v4, s[20:23], s56 offen offset:2048  lds
    buffer_load_dwordx4 v5, s[20:23], s56 offen offset:3072  lds
    s_add_u32 m0, s58, 0x18000
    s_nop 0
    buffer_load_dwordx4 v6, s[24:27], s57 offen offset:0  lds
    buffer_load_dwordx4 v7, s[24:27], s57 offen offset:1024  lds
    buffer_load_dwordx4 v6, s[24:27], s57 offen offset:2048  lds
    buffer_load_dwordx4 v7, s[24:27], s57 offen offset:3072  lds
    s_add_u32 m0, s63, 0x1c000
    s_nop 0
    buffer_load_dwordx4 v8, s[24:27], s57 offen offset:0  lds
    buffer_load_dwordx4 v9, s[24:27], s57 offen offset:1024  lds
    s_bfe_u32 s56, s94, 0x4001c
    s_add_u32 s56, s56, s64
    s_and_b32 s56, s56, 15
    s_mul_i32 s57, s56, 393216
    s_lshl_b32 s56, s56, 7
    s_load_dwordx2 s[90:91], s[80:81], 0x403c
    s_load_dwordx2 s[90:91], s[80:81], 0x40bc
    s_load_dwordx2 s[90:91], s[80:81], 0x413c
    s_waitcnt vmcnt(20)
    s_barrier
    s_add_u32 m0, s58, 0x1e000
    s_nop 0
    buffer_load_dwordx4 v2, s[20:23], s56 offen offset:0  lds
    buffer_load_dwordx4 v3, s[20:23], s56 offen offset:1024  lds
    buffer_load_dwordx4 v4, s[20:23], s56 offen offset:2048  lds
    buffer_load_dwordx4 v5, s[20:23], s56 offen offset:3072  lds
    s_add_u32 m0, s58, 0x22000
    s_nop 0
    buffer_load_dwordx4 v6, s[24:27], s57 offen offset:0  lds
    buffer_load_dwordx4 v7, s[24:27], s57 offen offset:1024  lds
    buffer_load_dwordx4 v6, s[24:27], s57 offen offset:2048  lds
    buffer_load_dwordx4 v7, s[24:27], s57 offen offset:3072  lds
    s_add_u32 m0, s63, 0x26000
    s_nop 0
    buffer_load_dwordx4 v8, s[24:27], s57 offen offset:0  lds
    buffer_load_dwordx4 v9, s[24:27], s57 offen offset:1024  lds
    s_bfe_u32 s56, s95, 0x40000
    s_add_u32 s56, s56, s64
    s_and_b32 s56, s56, 15
    s_mul_i32 s57, s56, 393216
    s_lshl_b32 s56, s56, 7
    s_load_dwordx2 s[90:91], s[80:81], 0x41bc
    s_load_dwordx2 s[90:91], s[80:81], 0x423c
    s_load_dwordx2 s[90:91], s[80:81], 0x42bc
    s_mov_b64 exec, 0xffff
    buffer_store_dwordx4 v[12:15], v11, s[40:43], s68 offen sc1
    s_mov_b64 exec, -1
    s_lshl2_add_u32 s52, s2, s62
    s_lshl_b32 s52, s52, 5
    s_add_u32 s52, s52, 0x850000
    buffer_load_dword v31, off, s[40:43], s52 sc1
    s_waitcnt vmcnt(22)
    s_barrier
    s_add_u32 m0, s58, 0x0
    s_nop 0
    buffer_load_dwordx4 v2, s[20:23], s56 offen offset:0  lds
    buffer_load_dwordx4 v3, s[20:23], s56 offen offset:1024  lds
    buffer_load_dwordx4 v4, s[20:23], s56 offen offset:2048  lds
    buffer_load_dwordx4 v5, s[20:23], s56 offen offset:3072  lds
    s_add_u32 m0, s58, 0x4000
    s_nop 0
    buffer_load_dwordx4 v6, s[24:27], s57 offen offset:0  lds
    buffer_load_dwordx4 v7, s[24:27], s57 offen offset:1024  lds
    buffer_load_dwordx4 v6, s[24:27], s57 offen offset:2048  lds
    buffer_load_dwordx4 v7, s[24:27], s57 offen offset:3072  lds
    s_add_u32 m0, s63, 0x8000
    s_nop 0
    buffer_load_dwordx4 v8, s[24:27], s57 offen offset:0  lds
    buffer_load_dwordx4 v9, s[24:27], s57 offen offset:1024  lds
    s_bfe_u32 s56, s95, 0x40004
    s_add_u32 s56, s56, s64
    s_and_b32 s56, s56, 15
    s_mul_i32 s57, s56, 393216
    s_lshl_b32 s56, s56, 7
    s_load_dwordx2 s[90:91], s[80:81], 0x433c
    s_load_dwordx2 s[90:91], s[80:81], 0x43bc
    s_load_dwordx2 s[90:91], s[80:81], 0x803c
    s_waitcnt vmcnt(22)
    s_barrier
    s_add_u32 m0, s58, 0xa000
    s_nop 0
    buffer_load_dwordx4 v2, s[20:23], s56 offen offset:0  lds
    buffer_load_dwordx4 v3, s[20:23], s56 offen offset:1024  lds
    buffer_load_dwordx4 v4, s[20:23], s56 offen offset:2048  lds
    buffer_load_dwordx4 v5, s[20:23], s56 offen offset:3072  lds
    s_add_u32 m0, s58, 0xe000
    s_nop 0
    buffer_load_dwordx4 v6, s[24:27], s57 offen offset:0  lds
    buffer_load_dwordx4 v7, s[24:27], s57 offen offset:1024  lds
    buffer_load_dwordx4 v6, s[24:27], s57 offen offset:2048  lds
    buffer_load_dwordx4 v7, s[24:27], s57 offen offset:3072  lds
    s_add_u32 m0, s63, 0x12000
    s_nop 0
    buffer_load_dwordx4 v8, s[24:27], s57 offen offset:0  lds
    buffer_load_dwordx4 v9, s[24:27], s57 offen offset:1024  lds
    s_bfe_u32 s56, s95, 0x40008
    s_add_u32 s56, s56, s64
    s_and_b32 s56, s56, 15
    s_mul_i32 s57, s56, 393216
    s_lshl_b32 s56, s56, 7
    s_load_dwordx2 s[90:91], s[80:81], 0x80bc
    s_load_dwordx2 s[90:91], s[80:81], 0x813c
    s_load_dwordx2 s[90:91], s[80:81], 0x81bc
    s_waitcnt vmcnt(22)
    s_barrier
    s_add_u32 m0, s58, 0x14000
    s_nop 0
    buffer_load_dwordx4 v2, s[20:23], s56 offen offset:0  lds
    buffer_load_dwordx4 v3, s[20:23], s56 offen offset:1024  lds
    buffer_load_dwordx4 v4, s[20:23], s56 offen offset:2048  lds
    buffer_load_dwordx4 v5, s[20:23], s56 offen offset:3072  lds
    s_add_u32 m0, s58, 0x18000
    s_nop 0
    buffer_load_dwordx4 v6, s[24:27], s57 offen offset:0  lds
    buffer_load_dwordx4 v7, s[24:27], s57 offen offset:1024  lds
    buffer_load_dwordx4 v6, s[24:27], s57 offen offset:2048  lds
    buffer_load_dwordx4 v7, s[24:27], s57 offen offset:3072  lds
    s_add_u32 m0, s63, 0x1c000
    s_nop 0
    buffer_load_dwordx4 v8, s[24:27], s57 offen offset:0  lds
    buffer_load_dwordx4 v9, s[24:27], s57 offen offset:1024  lds
    s_bfe_u32 s56, s95, 0x4000c
    s_add_u32 s56, s56, s64
    s_and_b32 s56, s56, 15
    s_mul_i32 s57, s56, 393216
    s_lshl_b32 s56, s56, 7
    s_load_dwordx2 s[90:91], s[80:81], 0x823c
    s_load_dwordx2 s[90:91], s[80:81], 0x82bc
    s_load_dwordx2 s[90:91], s[80:81], 0x833c
    s_waitcnt vmcnt(20)
    s_barrier
    s_add_u32 m0, s58, 0x1e000
    s_nop 0
    buffer_load_dwordx4 v2, s[20:23], s56 offen offset:0  lds
    buffer_load_dwordx4 v3, s[20:23], s56 offen offset:1024  lds
    buffer_load_dwordx4 v4, s[20:23], s56 offen offset:2048  lds
    buffer_load_dwordx4 v5, s[20:23], s56 offen offset:3072  lds
    s_add_u32 m0, s58, 0x22000
    s_nop 0
    buffer_load_dwordx4 v6, s[24:27], s57 offen offset:0  lds
    buffer_load_dwordx4 v7, s[24:27], s57 offen offset:1024  lds
    buffer_load_dwordx4 v6, s[24:27], s57 offen offset:2048  lds
    buffer_load_dwordx4 v7, s[24:27], s57 offen offset:3072  lds
    s_add_u32 m0, s63, 0x26000
    s_nop 0
    buffer_load_dwordx4 v8, s[24:27], s57 offen offset:0  lds
    buffer_load_dwordx4 v9, s[24:27], s57 offen offset:1024  lds
    s_bfe_u32 s56, s95, 0x40010
    s_add_u32 s56, s56, s64
    s_and_b32 s56, s56, 15
    s_mul_i32 s57, s56, 393216
    s_lshl_b32 s56, s56, 7
    s_load_dwordx2 s[90:91], s[80:81], 0x83bc
    s_load_dwordx2 s[90:91], s[80:81], 0xc03c
    s_load_dwordx2 s[90:91], s[80:81], 0xc0bc
    s_waitcnt vmcnt(20)
    s_barrier
    s_add_u32 m0, s58, 0x0
    s_nop 0
    buffer_load_dwordx4 v2, s[20:23], s56 offen offset:0  lds
    buffer_load_dwordx4 v3, s[20:23], s56 offen offset:1024  lds
    buffer_load_dwordx4 v4, s[20:23], s56 offen offset:2048  lds
    buffer_load_dwordx4 v5, s[20:23], s56 offen offset:3072  lds
    s_add_u32 m0, s58, 0x4000
    s_nop 0
    buffer_load_dwordx4 v6, s[24:27], s57 offen offset:0  lds
    buffer_load_dwordx4 v7, s[24:27], s57 offen offset:1024  lds
    buffer_load_dwordx4 v6, s[24:27], s57 offen offset:2048  lds
    buffer_load_dwordx4 v7, s[24:27], s57 offen offset:3072  lds
    s_add_u32 m0, s63, 0x8000
    s_nop 0
    buffer_load_dwordx4 v8, s[24:27], s57 offen offset:0  lds
    buffer_load_dwordx4 v9, s[24:27], s57 offen offset:1024  lds
    s_bfe_u32 s56, s95, 0x40014
    s_add_u32 s56, s56, s64
    s_and_b32 s56, s56, 15
    s_mul_i32 s57, s56, 393216
    s_lshl_b32 s56, s56, 7
    s_load_dwordx2 s[90:91], s[80:81], 0xc13c
    s_load_dwordx2 s[90:91], s[80:81], 0xc1bc
    s_load_dwordx2 s[90:91], s[80:81], 0xc23c
    s_waitcnt vmcnt(20)
    s_barrier
    s_add_u32 m0, s58, 0xa000
    s_nop 0
    buffer_load_dwordx4 v2, s[20:23], s56 offen offset:0  lds
    buffer_load_dwordx4 v3, s[20:23], s56 offen offset:1024  lds
    buffer_load_dwordx4 v4, s[20:23], s56 offen offset:2048  lds
    buffer_load_dwordx4 v5, s[20:23], s56 offen offset:3072  lds
    s_add_u32 m0, s58, 0xe000
    s_nop 0
    buffer_load_dwordx4 v6, s[24:27], s57 offen offset:0  lds
    buffer_load_dwordx4 v7, s[24:27], s57 offen offset:1024  lds
    buffer_load_dwordx4 v6, s[24:27], s57 offen offset:2048  lds
    buffer_load_dwordx4 v7, s[24:27], s57 offen offset:3072  lds
    s_add_u32 m0, s63, 0x12000
    s_nop 0
    buffer_load_dwordx4 v8, s[24:27], s57 offen offset:0  lds
    buffer_load_dwordx4 v9, s[24:27], s57 offen offset:1024  lds
    s_bfe_u32 s56, s95, 0x40018
    s_add_u32 s56, s56, s64
    s_and_b32 s56, s56, 15
    s_mul_i32 s57, s56, 393216
    s_lshl_b32 s56, s56, 7
    s_load_dwordx2 s[90:91], s[80:81], 0xc2bc
    s_load_dwordx2 s[90:91], s[80:81], 0xc33c
    s_load_dwordx2 s[90:91], s[80:81], 0xc3bc
    s_waitcnt vmcnt(20)
    s_barrier
    s_add_u32 m0, s58, 0x14000
    s_nop 0
    buffer_load_dwordx4 v2, s[20:23], s56 offen offset:0  lds
    buffer_load_dwordx4 v3, s[20:23], s56 offen offset:1024  lds
    buffer_load_dwordx4 v4, s[20:23], s56 offen offset:2048  lds
    buffer_load_dwordx4 v5, s[20:23], s56 offen offset:3072  lds
    s_add_u32 m0, s58, 0x18000
    s_nop 0
    buffer_load_dwordx4 v6, s[24:27], s57 offen offset:0  lds
    buffer_load_dwordx4 v7, s[24:27], s57 offen offset:1024  lds
    buffer_load_dwordx4 v6, s[24:27], s57 offen offset:2048  lds
    buffer_load_dwordx4 v7, s[24:27], s57 offen offset:3072  lds
    s_add_u32 m0, s63, 0x1c000
    s_nop 0
    buffer_load_dwordx4 v8, s[24:27], s57 offen offset:0  lds
    buffer_load_dwordx4 v9, s[24:27], s57 offen offset:1024  lds
    s_bfe_u32 s56, s95, 0x4001c
    s_add_u32 s56, s56, s64
    s_and_b32 s56, s56, 15
    s_mul_i32 s57, s56, 393216
    s_lshl_b32 s56, s56, 7
    s_load_dwordx2 s[90:91], s[82:83], 0x3c
    s_load_dwordx2 s[90:91], s[84:85], 0x3c
    s_waitcnt vmcnt(20)
    s_barrier
    s_add_u32 m0, s58, 0x1e000
    s_nop 0
    buffer_load_dwordx4 v2, s[20:23], s56 offen offset:0  lds
    buffer_load_dwordx4 v3, s[20:23], s56 offen offset:1024  lds
    buffer_load_dwordx4 v4, s[20:23], s56 offen offset:2048  lds
    buffer_load_dwordx4 v5, s[20:23], s56 offen offset:3072  lds
    s_add_u32 m0, s58, 0x22000
    s_nop 0
    buffer_load_dwordx4 v6, s[24:27], s57 offen offset:0  lds
    buffer_load_dwordx4 v7, s[24:27], s57 offen offset:1024  lds
    buffer_load_dwordx4 v6, s[24:27], s57 offen offset:2048  lds
    buffer_load_dwordx4 v7, s[24:27], s57 offen offset:3072  lds
    s_add_u32 m0, s63, 0x26000
    s_nop 0
    buffer_load_dwordx4 v8, s[24:27], s57 offen offset:0  lds
    buffer_load_dwordx4 v9, s[24:27], s57 offen offset:1024  lds
    s_load_dword s92, s[14:15], 0
    s_waitcnt vmcnt(20)
    s_barrier
    s_waitcnt lgkmcnt(0)
    s_cmp_eq_u32 s92, 0
    s_cbranch_scc1 L_tag
L_tag_ok:
    s_or_b32 s70, s70, s92
    v_mov_b32 v134, s70
    s_mov_b64 exec, 1
    buffer_store_dword v134, off, s[40:43], s78 sc1
    s_mov_b64 exec, -1
    v_mov_b32 v135, s92
    s_lshl_b32 s76, s92, 1
    s_bfe_u32 s4, s92, 0x80000
    s_mov_b32 s8, 0x7060500
    s_bfe_u32 s5, s92, 0x80008
    s_mov_b32 s9, 0x7060501
    s_bfe_u32 s6, s92, 0x80010
    s_mov_b32 s10, 0x7060502
    s_bfe_u32 s7, s92, 0x80018
    s_mov_b32 s11, 0x7060503
    s_or_b32 s53, s49, 1
    s_add_u32 s53, s53, 1
    s_add_u32 s52, s53, 0
    s_and_b32 s52, s52, 7
    s_lshl_b32 s80, s52, 11
    s_sub_u32 s52, s52, s50
    s_and_b32 s52, s52, 15
    s_lshl_b32 s88, s52, 13
    s_add_u32 s52, s53, 1
    s_and_b32 s52, s52, 7
    s_lshl_b32 s81, s52, 11
    s_sub_u32 s52, s52, s50
    s_and_b32 s52, s52, 15
    s_lshl_b32 s89, s52, 13
    s_add_u32 s52, s53, 2
    s_and_b32 s52, s52, 7
    s_lshl_b32 s82, s52, 11
    s_sub_u32 s52, s52, s50
    s_and_b32 s52, s52, 15
    s_lshl_b32 s90, s52, 13
    s_add_u32 s52, s53, 3
    s_and_b32 s52, s52, 7
    s_lshl_b32 s83, s52, 11
    s_sub_u32 s52, s52, s50
    s_and_b32 s52, s52, 15
    s_lshl_b32 s91, s52, 13
    s_add_u32 s52, s53, 4
    s_and_b32 s52, s52, 7
    s_lshl_b32 s84, s52, 11
    s_sub_u32 s52, s52, s50
    s_and_b32 s52, s52, 15
    s_lshl_b32 s94, s52, 13
    s_add_u32 s52, s53, 5
    s_and_b32 s52, s52, 7
    s_lshl_b32 s85, s52, 11
    s_sub_u32 s52, s52, s50
    s_and_b32 s52, s52, 15
    s_lshl_b32 s95, s52, 13
    s_add_u32 s52, s53, 6
    s_and_b32 s52, s52, 7
    s_lshl_b32 s86, s52, 11
    s_sub_u32 s52, s52, s50
    s_and_b32 s52, s52, 15
    s_lshl_b32 s96, s52, 13
    s_add_u32 s52, s53, 7
    s_and_b32 s52, s52, 7
    s_lshl_b32 s87, s52, 11
    s_sub_u32 s52, s52, s50
    s_and_b32 s52, s52, 15
    s_lshl_b32 s97, s52, 13
    v_add_u32 v246, s88, v242
    v_add_u32 v247, s88, v243
    v_add_u32 v248, s88, v244
    v_add_u32 v249, s88, v245
    s_add_u32 s77, s71, 0
    s_and_b32 s77, s77, 31
    s_lshl_b32 s77, s77, 16
    s_add_u32 m0, s58, 0x0
    s_nop 0
    buffer_load_dwordx4 v128, s[32:35], s77 offen offset:0  lds
    buffer_load_dwordx4 v129, s[32:35], s77 offen offset:1024  lds
    buffer_load_dwordx4 v130, s[32:35], s77 offen offset:2048  lds
    buffer_load_dwordx4 v131, s[32:35], s77 offen offset:3072  lds
    s_waitcnt vmcnt(15)
    s_barrier
    s_add_u32 s77, s71, 4
    s_and_b32 s77, s77, 31
    s_lshl_b32 s77, s77, 16
    s_add_u32 m0, s58, 0x4000
    s_nop 0
    buffer_load_dwordx4 v128, s[32:35], s77 offen offset:0  lds
    buffer_load_dwordx4 v129, s[32:35], s77 offen offset:1024  lds
    buffer_load_dwordx4 v130, s[32:35], s77 offen offset:2048  lds
    buffer_load_dwordx4 v131, s[32:35], s77 offen offset:3072  lds
    s_add_u32 s77, s71, 8
    s_and_b32 s77, s77, 31
    s_lshl_b32 s77, s77, 16
    s_add_u32 m0, s58, 0x8000
    s_nop 0
    buffer_load_dwordx4 v128, s[32:35], s77 offen offset:0  lds
    buffer_load_dwordx4 v129, s[32:35], s77 offen offset:1024  lds
    buffer_load_dwordx4 v130, s[32:35], s77 offen offset:2048  lds
    buffer_load_dwordx4 v131, s[32:35], s77 offen offset:3072  lds
    s_waitcnt vmcnt(13)
    s_barrier
    s_add_u32 s77, s71, 12
    s_and_b32 s77, s77, 31
    s_lshl_b32 s77, s77, 16
    s_add_u32 m0, s58, 0xc000
    s_nop 0
    buffer_load_dwordx4 v128, s[32:35], s77 offen offset:0  lds
    buffer_load_dwordx4 v129, s[32:35], s77 offen offset:1024  lds
    buffer_load_dwordx4 v130, s[32:35], s77 offen offset:2048  lds
    buffer_load_dwordx4 v131, s[32:35], s77 offen offset:3072  lds
    s_add_u32 s77, s71, 16
    s_and_b32 s77, s77, 31
    s_lshl_b32 s77, s77, 16
    s_add_u32 m0, s58, 0x10000
    s_nop 0
    buffer_load_dwordx4 v128, s[32:35], s77 offen offset:0  lds
    buffer_load_dwordx4 v129, s[32:35], s77 offen offset:1024  lds
    buffer_load_dwordx4 v130, s[32:35], s77 offen offset:2048  lds
    buffer_load_dwordx4 v131, s[32:35], s77 offen offset:3072  lds
    s_barrier
    buffer_load_dwordx4 v[36:39], v132, s[40:43], 0 offen sc1
    s_add_u32 s77, s71, 20
    s_and_b32 s77, s77, 31
    s_lshl_b32 s77, s77, 16
    s_add_u32 m0, s58, 0x14000
    s_nop 0
    buffer_load_dwordx4 v128, s[32:35], s77 offen offset:0  lds
    buffer_load_dwordx4 v129, s[32:35], s77 offen offset:1024  lds
    buffer_load_dwordx4 v130, s[32:35], s77 offen offset:2048  lds
    buffer_load_dwordx4 v131, s[32:35], s77 offen offset:3072  lds
    s_add_u32 s77, s71, 24
    s_and_b32 s77, s77, 31
    s_lshl_b32 s77, s77, 16
    s_add_u32 m0, s58, 0x18000
    s_nop 0
    buffer_load_dwordx4 v128, s[32:35], s77 offen offset:0  lds
    buffer_load_dwordx4 v129, s[32:35], s77 offen offset:1024  lds
    buffer_load_dwordx4 v130, s[32:35], s77 offen offset:2048  lds
    buffer_load_dwordx4 v131, s[32:35], s77 offen offset:3072  lds
    s_add_u32 s77, s71, 28
    s_and_b32 s77, s77, 31
    s_lshl_b32 s77, s77, 16
    buffer_load_dwordx4 v[112:115], v128, s[32:35], s77 offen offset:0
    buffer_load_dwordx4 v[116:119], v129, s[32:35], s77 offen offset:1024
    buffer_load_dwordx4 v[120:123], v130, s[32:35], s77 offen offset:2048
    buffer_load_dwordx4 v[124:127], v131, s[32:35], s77 offen offset:3072
    s_add_u32 s67, s66, 0x4000
    s_add_u32 s53, s66, 0x8000
    s_add_u32 s54, s66, 0xc000
    s_movk_i32 s55, 0x1000
    s_movk_i32 s56, 0x2000
    s_movk_i32 s63, 0x3000
    s_mov_b32 s64, 0xffff0000
    s_mov_b32 s65, 0xffff0000
    s_mov_b32 s93, 1
    s_barrier
    ds_read_b64_tr_b16 v[64:65], v18 offset:0
    ds_read_b64_tr_b16 v[66:67], v18 offset:1024
    ds_read_b64_tr_b16 v[68:69], v19 offset:0
    ds_read_b64_tr_b16 v[70:71], v19 offset:1024
    ds_read_b64_tr_b16 v[72:73], v20 offset:0
    ds_read_b64_tr_b16 v[74:75], v20 offset:1024
    ds_read_b64_tr_b16 v[76:77], v21 offset:0
    ds_read_b64_tr_b16 v[78:79], v21 offset:1024
    ds_read_b64_tr_b16 v[80:81], v18 offset:2048
    ds_read_b64_tr_b16 v[82:83], v18 offset:3072
    ds_read_b64_tr_b16 v[84:85], v19 offset:2048
    ds_read_b64_tr_b16 v[86:87], v19 offset:3072
    ds_read_b64_tr_b16 v[88:89], v20 offset:2048
    ds_read_b64_tr_b16 v[90:91], v20 offset:3072
    ds_read_b64_tr_b16 v[92:93], v21 offset:2048
    s_waitcnt lgkmcnt(7)
    ds_read_b64_tr_b16 v[94:95], v21 offset:3072
    ds_read_b64_tr_b16 v[96:97], v18 offset:16384
    ds_read_b64_tr_b16 v[98:99], v18 offset:17408
    ds_read_b64_tr_b16 v[100:101], v19 offset:16384
    ds_read_b64_tr_b16 v[102:103], v19 offset:17408
    ds_read_b64_tr_b16 v[104:105], v20 offset:4096
    ds_read_b64_tr_b16 v[106:107], v20 offset:5120
    ds_read_b64_tr_b16 v[108:109], v21 offset:4096
    v_mfma_f32_16x16x32_bf16 v[40:43], v[64:67], v[72:75], 0
    v_mfma_f32_16x16x32_bf16 v[44:47], v[68:71], v[72:75], 0
    v_mfma_f32_16x16x32_bf16 v[48:51], v[64:67], v[76:79], 0
    v_mfma_f32_16x16x32_bf16 v[52:55], v[68:71], v[76:79], 0
    v_mfma_f32_16x16x32_bf16 v[56:59], v[32:35], v[64:67], 0
    v_mfma_f32_16x16x32_bf16 v[60:63], v[32:35], v[68:71], 0
    s_waitcnt lgkmcnt(7)
    ds_read_b64_tr_b16 v[110:111], v21 offset:5120
    ds_read_b64_tr_b16 v[64:65], v18 offset:18432
    ds_read_b64_tr_b16 v[66:67], v18 offset:19456
    ds_read_b64_tr_b16 v[68:69], v19 offset:18432
    ds_read_b64_tr_b16 v[70:71], v19 offset:19456
    ds_read_b64_tr_b16 v[72:73], v20 offset:6144
    ds_read_b64_tr_b16 v[74:75], v20 offset:7168
    ds_read_b64_tr_b16 v[76:77], v21 offset:6144
    v_mfma_f32_16x16x32_bf16 v[40:43], v[80:83], v[88:91], v[40:43]
    v_mfma_f32_16x16x32_bf16 v[44:47], v[84:87], v[88:91], v[44:47]
    v_mfma_f32_16x16x32_bf16 v[48:51], v[80:83], v[92:95], v[48:51]
    v_mfma_f32_16x16x32_bf16 v[52:55], v[84:87], v[92:95], v[52:55]
    v_mfma_f32_16x16x32_bf16 v[56:59], v[32:35], v[80:83], v[56:59]
    v_mfma_f32_16x16x32_bf16 v[60:63], v[32:35], v[84:87], v[60:63]
    s_waitcnt lgkmcnt(7)
    ds_read_b64_tr_b16 v[78:79], v21 offset:7168
    s_waitcnt vmcnt(12)
    v_mfma_f32_16x16x32_bf16 v[40:43], v[96:99], v[104:107], v[40:43]
    v_xor_b32 v36, s70, v36
    v_xor_b32 v37, s70, v37
    v_mfma_f32_16x16x32_bf16 v[44:47], v[100:103], v[104:107], v[44:47]
    v_xor_b32 v38, s70, v38
    v_xor_b32 v39, s70, v39
    v_mfma_f32_16x16x32_bf16 v[48:51], v[96:99], v[108:111], v[48:51]
    v_or3_b32 v36, v36, v37, v38
    v_or_b32 v36, v36, v39
    v_mfma_f32_16x16x32_bf16 v[52:55], v[100:103], v[108:111], v[52:55]
    v_cmp_ne_u32 vcc, 0, v36
    v_mfma_f32_16x16x32_bf16 v[56:59], v[32:35], v[96:99], v[56:59]
    v_mfma_f32_16x16x32_bf16 v[60:63], v[32:35], v[100:103], v[60:63]
    s_waitcnt lgkmcnt(0)
    v_mfma_f32_16x16x32_bf16 v[40:43], v[64:67], v[72:75], v[40:43]
    v_mfma_f32_16x16x32_bf16 v[44:47], v[68:71], v[72:75], v[44:47]
    v_mfma_f32_16x16x32_bf16 v[48:51], v[64:67], v[76:79], v[48:51]
    v_mfma_f32_16x16x32_bf16 v[52:55], v[68:71], v[76:79], v[52:55]
    v_mfma_f32_16x16x32_bf16 v[56:59], v[32:35], v[64:67], v[56:59]
    v_mfma_f32_16x16x32_bf16 v[60:63], v[32:35], v[68:71], v[60:63]
    s_cbranch_vccnz L_slow
L_loc:
    s_nop 1
    v_perm_b32 v40, v40, v135, s8
    v_perm_b32 v41, v41, v135, s9
    v_perm_b32 v42, v42, v135, s10
    v_perm_b32 v43, v43, v135, s11
    buffer_store_dwordx4 v[40:43], v10, s[36:39], s66 offen
    v_perm_b32 v44, v44, v135, s8
    v_perm_b32 v45, v45, v135, s9
    v_perm_b32 v46, v46, v135, s10
    v_perm_b32 v47, v47, v135, s11
    buffer_store_dwordx4 v[44:47], v10, s[36:39], s67 offen
    v_perm_b32 v48, v48, v135, s8
    v_perm_b32 v49, v49, v135, s9
    v_perm_b32 v50, v50, v135, s10
    v_perm_b32 v51, v51, v135, s11
    buffer_store_dwordx4 v[48:51], v10, s[36:39], s53 offen
    v_perm_b32 v52, v52, v135, s8
    v_perm_b32 v53, v53, v135, s9
    v_perm_b32 v54, v54, v135, s10
    v_perm_b32 v55, v55, v135, s11
    buffer_store_dwordx4 v[52:55], v10, s[36:39], s54 offen
    v_cndmask_b32 v56, v56, v60, s[64:65]
    s_mov_b32 exec_hi, 0
    buffer_store_dword v56, v136, s[40:43], s68 offen
    s_mov_b32 exec_hi, -1
L_sp_j:
    ds_write_b32 v25, v135 offset:2112
    s_mov_b32 s59, 0x10000
L_poll_1:
    buffer_load_dwordx4 v[80:83], v10, s[40:43], s75 offen offset:0 sc1
    buffer_load_dwordx4 v[84:87], v10, s[40:43], s75 offen offset:1024 sc1
    buffer_load_dwordx4 v[64:67], v22, s[36:39], 0 offen sc1
    buffer_load_dwordx4 v[68:71], v22, s[36:39], s55 offen sc1
    buffer_load_dwordx4 v[72:75], v22, s[36:39], s56 offen sc1
    buffer_load_dwordx4 v[76:79], v22, s[36:39], s63 offen sc1
    s_waitcnt vmcnt(0)
    v_max3_u32 v28, v80, v81, v82
    v_max3_u32 v29, v83, v84, v85
    v_max3_u32 v28, v28, v86, v87
    v_max_u32 v28, v28, v29
    v_cmp_eq_u32 s[64:65], -1, v28
    v_xor_b32 v64, s4, v64
    v_xor_b32 v65, s5, v65
    v_xor_b32 v66, s6, v66
    v_xor_b32 v67, s7, v67
    v_xor_b32 v68, s4, v68
    v_xor_b32 v69, s5, v69
    v_xor_b32 v70, s6, v70
    v_xor_b32 v71, s7, v71
    v_xor_b32 v72, s4, v72
    v_xor_b32 v73, s5, v73
    v_xor_b32 v74, s6, v74
    v_xor_b32 v75, s7, v75
    v_xor_b32 v76, s4, v76
    v_xor_b32 v77, s5, v77
    v_xor_b32 v78, s6, v78
    v_xor_b32 v79, s7, v79
    v_or3_b32 v26, v64, v65, v66
    v_or3_b32 v27, v67, v68, v69
    v_or3_b32 v26, v26, v70, v71
    v_or3_b32 v27, v27, v72, v73
    v_or3_b32 v26, v26, v74, v75
    v_or3_b32 v27, v27, v76, v77
    v_or3_b32 v26, v26, v78, v79
    v_or_b32 v26, v26, v27
    v_and_b32 v26, 0xff, v26
    v_cmp_ne_u32 vcc, 0, v26
    s_or_b64 vcc, vcc, s[64:65]
    s_cbranch_vccz L_poll_1_ok
    s_mov_b64 exec, vcc
    s_sub_u32 s59, s59, 1
    s_cbranch_scc0 L_poll_1
L_poll_1_ok:
    s_mov_b64 exec, -1
    v_pk_add_f32 v[64:65], v[64:65], v[68:69]
    v_pk_add_f32 v[72:73], v[72:73], v[76:77]
    v_pk_add_f32 v[66:67], v[66:67], v[70:71]
    v_pk_add_f32 v[74:75], v[74:75], v[78:79]
    v_pk_add_f32 v[64:65], v[64:65], v[72:73]
    v_pk_add_f32 v[66:67], v[66:67], v[74:75]
    s_nop 1
    v_permlane32_swap_b32 v64, v66
    v_permlane32_swap_b32 v65, v67
    v_pk_add_f32 v[64:65], v[64:65], v[66:67]
    v_mov_b32 v66, v64
    v_mov_b32 v67, v65
    s_nop 0
    v_permlane16_swap_b32 v64, v66
    v_permlane16_swap_b32 v65, v67
    v_pk_add_f32 v[64:65], v[64:65], v[66:67]
    v_cvt_pk_bf16_f32 v64, v64, v65
    s_cmp_eq_u32 s93, 0
    s_cbranch_scc1 L_sf_x
    buffer_store_dword v64, v24, s[40:43], s69 offen
L_sf_j:
    v_pk_add_f32 v[80:81], v[80:81], v[84:85]
    v_pk_add_f32 v[82:83], v[82:83], v[86:87]
    s_nop 1
    v_permlane32_swap_b32 v80, v82
    v_permlane32_swap_b32 v81, v83
    v_pk_add_f32 v[80:81], v[80:81], v[82:83]
    v_mov_b32 v82, v80
    v_mov_b32 v83, v81
    s_nop 0
    v_permlane16_swap_b32 v80, v82
    v_permlane16_swap_b32 v81, v83
    v_pk_add_f32 v[80:81], v[80:81], v[82:83]
    s_nop 1
    v_add_f32_dpp v80, v80, v80 row_ror:8 row_mask:0xf bank_mask:0xf
    v_add_f32_dpp v81, v81, v81 row_ror:8 row_mask:0xf bank_mask:0xf
    v_cvt_pk_bf16_f32 v80, v80, v81
    ds_write_b32 v25, v80 offset:2048
    s_waitcnt lgkmcnt(0)
    s_barrier
    ds_write_b128 v143, v[112:115] offset:49152
    ds_write_b128 v143, v[116:119] offset:50176
    ds_write_b128 v143, v[120:123] offset:51200
    ds_write_b128 v143, v[124:127] offset:52224
    s_waitcnt lgkmcnt(0)
    s_branch L_p3
L_cwave:
    s_and_b32 s60, s3, 1
    s_bfe_u32 s61, s3, 0x10001
    v_and_b32 v26, 15, v1
    v_lshrrev_b32 v27, 4, v1
    v_bfe_u32 v28, v1, 1, 3
    v_xor_b32 v28, v28, v27
    v_lshlrev_b32 v28, 4, v28
    v_lshl_add_u32 v28, v26, 7, v28
    s_lshl_b32 s54, s61, 13
    v_add_u32 v2, s54, v28
    v_xor_b32 v3, 64, v2
    v_bfe_u32 v28, v1, 2, 2
    v_bfe_u32 v29, v1, 4, 1
    v_lshl_add_u32 v28, v29, 3, v28
    v_lshlrev_b32 v28, 7, v28
    v_bfe_u32 v29, v1, 3, 2
    s_lshl_b32 s54, s60, 1
    v_xor_b32 v29, s54, v29
    v_lshl_add_u32 v28, v29, 5, v28
    v_and_b32 v29, 3, v1
    v_lshl_add_u32 v28, v29, 3, v28
    v_lshrrev_b32 v29, 5, v1
    v_lshl_add_u32 v6, v29, 12, v28
    v_lshl_add_u32 v10, v29, 11, v28
    v_add_u32 v6, 0x4000, v6
    v_add_u32 v10, 0x8000, v10
    v_xor_b32 v7, 32, v6
    v_xor_b32 v11, 32, v10
    v_add_u32 v4, 0x14000, v2
    v_add_u32 v5, 0x14000, v3
    v_add_u32 v8, 0x14000, v6
    v_add_u32 v9, 0x14000, v7
    v_add_u32 v12, 0x14000, v10
    v_add_u32 v13, 0x14000, v11
    v_mov_b64 v[32:33], 0
    v_mov_b64 v[34:35], 0
    v_mov_b64 v[36:37], 0
    v_mov_b64 v[38:39], 0
    v_mov_b64 v[40:41], 0
    v_mov_b64 v[42:43], 0
    v_mov_b64 v[44:45], 0
    v_mov_b64 v[46:47], 0
    v_mov_b64 v[48:49], 0
    v_mov_b64 v[50:51], 0
    v_mov_b64 v[52:53], 0
    v_mov_b64 v[54:55], 0
    v_mov_b64 v[56:57], 0
    v_mov_b64 v[58:59], 0
    v_mov_b64 v[60:61], 0
    v_mov_b64 v[62:63], 0
    v_mov_b64 v[64:65], 0
    v_mov_b64 v[66:67], 0
    v_mov_b64 v[68:69], 0
    v_mov_b64 v[70:71], 0
    v_mov_b64 v[72:73], 0
    v_mov_b64 v[74:75], 0
    v_mov_b64 v[76:77], 0
    v_mov_b64 v[78:79], 0
    v_mov_b64 v[80:81], 0
    v_mov_b64 v[82:83], 0
    v_mov_b64 v[84:85], 0
    v_mov_b64 v[86:87], 0
    v_mov_b64 v[88:89], 0
    v_mov_b64 v[90:91], 0
    v_mov_b64 v[92:93], 0
    v_mov_b64 v[94:95], 0
    v_mov_b64 v[96:97], 0
    v_mov_b64 v[98:99], 0
    v_mov_b64 v[100:101], 0
    v_mov_b64 v[102:103], 0
    v_mov_b64 v[104:105], 0
    v_mov_b64 v[106:107], 0
    v_mov_b64 v[108:109], 0
    v_mov_b64 v[110:111], 0
    v_mov_b64 v[112:113], 0
    v_mov_b64 v[114:115], 0
    v_mov_b64 v[116:117], 0
    v_mov_b64 v[118:119], 0
    v_mov_b64 v[120:121], 0
    v_mov_b64 v[122:123], 0
    v_mov_b64 v[124:125], 0
    v_mov_b64 v[126:127], 0
    s_waitcnt lgkmcnt(0)
    v_lshrrev_b32 v28, 2, v1
    v_and_b32 v29, 3, v1
    v_lshlrev_b32 v29, 3, v29
    v_lshl_add_u32 v28, v28, 6, v29
    s_lshl_b32 s53, s60, 11
    s_add_u32 s53, s53, 0x26000
    v_add_u32 v28, s53, v28
    s_lshl3_add_u32 s52, s2, s3
    s_cmp_eq_u32 s52, 4
    s_cbranch_scc1 L_mktag
L_notag:
    s_barrier
    ds_read_b64_tr_b16 v[14:15], v28 offset:0
    ds_read_b64_tr_b16 v[16:17], v28 offset:1024
    ds_read_b64_tr_b16 v[18:19], v28 offset:32
    ds_read_b64_tr_b16 v[20:21], v28 offset:1056
    ds_read_b128 v[128:131], v2 offset:0
    ds_read_b64_tr_b16 v[200:201], v6 offset:0
    ds_read_b64_tr_b16 v[202:203], v6 offset:512
    ds_read_b128 v[132:135], v3 offset:0
    ds_read_b64_tr_b16 v[204:205], v6 offset:8192
    ds_read_b64_tr_b16 v[206:207], v6 offset:8704
    ds_read_b128 v[140:143], v3 offset:2048
    ds_read_b128 v[136:139], v2 offset:2048
    ds_read_b128 v[144:147], v2 offset:4096
    ds_read_b128 v[148:151], v3 offset:4096
    ds_read_b128 v[156:159], v3 offset:6144
    s_waitcnt lgkmcnt(9)
    ds_read_b128 v[152:155], v2 offset:6144
    ds_read_b64_tr_b16 v[208:209], v7 offset:0
    ds_read_b64_tr_b16 v[210:211], v7 offset:512
    ds_read_b64_tr_b16 v[212:213], v7 offset:8192
    ds_read_b64_tr_b16 v[214:215], v7 offset:8704
    ds_read_b64_tr_b16 v[216:217], v6 offset:2048
    s_mov_b32 s59, 3
.p2align 6
L_c1:
    s_waitcnt lgkmcnt(9)
    v_mfma_f32_16x16x32_bf16 v[32:35], v[200:203], v[128:131], v[32:35]
    ds_read_b64_tr_b16 v[218:219], v6 offset:2560
    v_mfma_f32_16x16x32_bf16 v[32:35], v[204:207], v[132:135], v[32:35]
    ds_read_b64_tr_b16 v[220:221], v6 offset:10240
    v_mfma_f32_16x16x32_bf16 v[36:39], v[204:207], v[140:143], v[36:39]
    ds_read_b64_tr_b16 v[222:223], v6 offset:10752
    v_mfma_f32_16x16x32_bf16 v[36:39], v[200:203], v[136:139], v[36:39]
    ds_read_b64_tr_b16 v[224:225], v7 offset:2048
    s_waitcnt lgkmcnt(9)
    v_mfma_f32_16x16x32_bf16 v[40:43], v[200:203], v[144:147], v[40:43]
    ds_read_b64_tr_b16 v[226:227], v7 offset:2560
    v_mfma_f32_16x16x32_bf16 v[40:43], v[204:207], v[148:151], v[40:43]
    ds_read_b64_tr_b16 v[228:229], v7 offset:10240
    v_mfma_f32_16x16x32_bf16 v[44:47], v[204:207], v[156:159], v[44:47]
    ds_read_b64_tr_b16 v[230:231], v7 offset:10752
    v_mfma_f32_16x16x32_bf16 v[44:47], v[200:203], v[152:155], v[44:47]
    ds_read_b64_tr_b16 v[200:201], v10 offset:0
    s_waitcnt lgkmcnt(9)
    v_mfma_f32_16x16x32_bf16 v[60:63], v[208:211], v[152:155], v[60:63]
    ds_read_b64_tr_b16 v[202:203], v10 offset:512
    v_mfma_f32_16x16x32_bf16 v[60:63], v[212:215], v[156:159], v[60:63]
    ds_read_b64_tr_b16 v[204:205], v10 offset:4096
    v_mfma_f32_16x16x32_bf16 v[56:59], v[212:215], v[148:151], v[56:59]
    ds_read_b64_tr_b16 v[206:207], v10 offset:4608
    v_mfma_f32_16x16x32_bf16 v[56:59], v[208:211], v[144:147], v[56:59]
    v_mfma_f32_16x16x32_bf16 v[52:55], v[208:211], v[136:139], v[52:55]
    v_mfma_f32_16x16x32_bf16 v[52:55], v[212:215], v[140:143], v[52:55]
    v_mfma_f32_16x16x32_bf16 v[48:51], v[212:215], v[132:135], v[48:51]
    v_mfma_f32_16x16x32_bf16 v[48:51], v[208:211], v[128:131], v[48:51]
    ds_read_b64_tr_b16 v[208:209], v11 offset:0
    s_waitcnt lgkmcnt(9)
    v_mfma_f32_16x16x32_bf16 v[64:67], v[216:219], v[128:131], v[64:67]
    ds_read_b64_tr_b16 v[210:211], v11 offset:512
    v_mfma_f32_16x16x32_bf16 v[64:67], v[220:223], v[132:135], v[64:67]
    ds_read_b64_tr_b16 v[212:213], v11 offset:4096
    v_mfma_f32_16x16x32_bf16 v[68:71], v[220:223], v[140:143], v[68:71]
    ds_read_b64_tr_b16 v[214:215], v11 offset:4608
    v_mfma_f32_16x16x32_bf16 v[68:71], v[216:219], v[136:139], v[68:71]
    v_mfma_f32_16x16x32_bf16 v[72:75], v[216:219], v[144:147], v[72:75]
    v_mfma_f32_16x16x32_bf16 v[72:75], v[220:223], v[148:151], v[72:75]
    v_mfma_f32_16x16x32_bf16 v[76:79], v[220:223], v[156:159], v[76:79]
    v_mfma_f32_16x16x32_bf16 v[76:79], v[216:219], v[152:155], v[76:79]
    s_waitcnt lgkmcnt(8)
    v_mfma_f32_16x16x32_bf16 v[92:95], v[224:227], v[152:155], v[92:95]
    v_mfma_f32_16x16x32_bf16 v[92:95], v[228:231], v[156:159], v[92:95]
    v_mfma_f32_16x16x32_bf16 v[88:91], v[228:231], v[148:151], v[88:91]
    v_mfma_f32_16x16x32_bf16 v[88:91], v[224:227], v[144:147], v[88:91]
    v_mfma_f32_16x16x32_bf16 v[84:87], v[224:227], v[136:139], v[84:87]
    v_mfma_f32_16x16x32_bf16 v[84:87], v[228:231], v[140:143], v[84:87]
    v_mfma_f32_16x16x32_bf16 v[80:83], v[228:231], v[132:135], v[80:83]
    v_mfma_f32_16x16x32_bf16 v[80:83], v[224:227], v[128:131], v[80:83]
    s_waitcnt lgkmcnt(0)
    s_barrier
    ds_read_b128 v[168:171], v2 offset:40960
    v_mfma_f32_16x16x32_bf16 v[96:99], v[200:203], v[128:131], v[96:99]
    ds_read_b64_tr_b16 v[216:217], v6 offset:40960
    v_mfma_f32_16x16x32_bf16 v[96:99], v[204:207], v[132:135], v[96:99]
    ds_read_b64_tr_b16 v[218:219], v6 offset:41472
    v_mfma_f32_16x16x32_bf16 v[100:103], v[204:207], v[140:143], v[100:103]
    ds_read_b128 v[172:175], v3 offset:40960
    v_mfma_f32_16x16x32_bf16 v[100:103], v[200:203], v[136:139], v[100:103]
    ds_read_b64_tr_b16 v[220:221], v6 offset:49152
    v_mfma_f32_16x16x32_bf16 v[104:107], v[200:203], v[144:147], v[104:107]
    ds_read_b64_tr_b16 v[222:223], v6 offset:49664
    v_mfma_f32_16x16x32_bf16 v[104:107], v[204:207], v[148:151], v[104:107]
    ds_read_b128 v[180:183], v3 offset:43008
    v_mfma_f32_16x16x32_bf16 v[108:111], v[204:207], v[156:159], v[108:111]
    ds_read_b128 v[176:179], v2 offset:43008
    v_mfma_f32_16x16x32_bf16 v[108:111], v[200:203], v[152:155], v[108:111]
    ds_read_b128 v[184:187], v2 offset:45056
    v_mfma_f32_16x16x32_bf16 v[124:127], v[208:211], v[152:155], v[124:127]
    ds_read_b128 v[188:191], v3 offset:45056
    v_mfma_f32_16x16x32_bf16 v[124:127], v[212:215], v[156:159], v[124:127]
    ds_read_b128 v[196:199], v3 offset:47104
    v_mfma_f32_16x16x32_bf16 v[120:123], v[212:215], v[148:151], v[120:123]
    ds_read_b128 v[192:195], v2 offset:47104
    v_mfma_f32_16x16x32_bf16 v[120:123], v[208:211], v[144:147], v[120:123]
    ds_read_b64_tr_b16 v[224:225], v7 offset:40960
    v_mfma_f32_16x16x32_bf16 v[116:119], v[208:211], v[136:139], v[116:119]
    ds_read_b64_tr_b16 v[226:227], v7 offset:41472
    v_mfma_f32_16x16x32_bf16 v[116:119], v[212:215], v[140:143], v[116:119]
    ds_read_b64_tr_b16 v[228:229], v7 offset:49152
    v_mfma_f32_16x16x32_bf16 v[112:115], v[212:215], v[132:135], v[112:115]
    s_waitcnt lgkmcnt(13)
    ds_read_b64_tr_b16 v[230:231], v7 offset:49664
    v_mfma_f32_16x16x32_bf16 v[112:115], v[208:211], v[128:131], v[112:115]
    ds_read_b64_tr_b16 v[200:201], v6 offset:43008
    s_waitcnt lgkmcnt(9)
    v_mfma_f32_16x16x32_bf16 v[32:35], v[216:219], v[168:171], v[32:35]
    ds_read_b64_tr_b16 v[202:203], v6 offset:43520
    v_mfma_f32_16x16x32_bf16 v[32:35], v[220:223], v[172:175], v[32:35]
    ds_read_b64_tr_b16 v[204:205], v6 offset:51200
    v_mfma_f32_16x16x32_bf16 v[36:39], v[220:223], v[180:183], v[36:39]
    ds_read_b64_tr_b16 v[206:207], v6 offset:51712
    v_mfma_f32_16x16x32_bf16 v[36:39], v[216:219], v[176:179], v[36:39]
    ds_read_b64_tr_b16 v[208:209], v7 offset:43008
    s_waitcnt lgkmcnt(9)
    v_mfma_f32_16x16x32_bf16 v[40:43], v[216:219], v[184:187], v[40:43]
    ds_read_b64_tr_b16 v[210:211], v7 offset:43520
    v_mfma_f32_16x16x32_bf16 v[40:43], v[220:223], v[188:191], v[40:43]
    ds_read_b64_tr_b16 v[212:213], v7 offset:51200
    v_mfma_f32_16x16x32_bf16 v[44:47], v[220:223], v[196:199], v[44:47]
    ds_read_b64_tr_b16 v[214:215], v7 offset:51712
    v_mfma_f32_16x16x32_bf16 v[44:47], v[216:219], v[192:195], v[44:47]
    ds_read_b64_tr_b16 v[216:217], v10 offset:40960
    s_waitcnt lgkmcnt(9)
    v_mfma_f32_16x16x32_bf16 v[60:63], v[224:227], v[192:195], v[60:63]
    ds_read_b64_tr_b16 v[218:219], v10 offset:41472
    v_mfma_f32_16x16x32_bf16 v[60:63], v[228:231], v[196:199], v[60:63]
    ds_read_b64_tr_b16 v[220:221], v10 offset:45056
    v_mfma_f32_16x16x32_bf16 v[56:59], v[228:231], v[188:191], v[56:59]
    ds_read_b64_tr_b16 v[222:223], v10 offset:45568
    v_mfma_f32_16x16x32_bf16 v[56:59], v[224:227], v[184:187], v[56:59]
    v_mfma_f32_16x16x32_bf16 v[52:55], v[224:227], v[176:179], v[52:55]
    v_mfma_f32_16x16x32_bf16 v[52:55], v[228:231], v[180:183], v[52:55]
    v_mfma_f32_16x16x32_bf16 v[48:51], v[228:231], v[172:175], v[48:51]
    v_mfma_f32_16x16x32_bf16 v[48:51], v[224:227], v[168:171], v[48:51]
    ds_read_b64_tr_b16 v[224:225], v11 offset:40960
    s_waitcnt lgkmcnt(9)
    v_mfma_f32_16x16x32_bf16 v[64:67], v[200:203], v[168:171], v[64:67]
    ds_read_b64_tr_b16 v[226:227], v11 offset:41472
    v_mfma_f32_16x16x32_bf16 v[64:67], v[204:207], v[172:175], v[64:67]
    ds_read_b64_tr_b16 v[228:229], v11 offset:45056
    v_mfma_f32_16x16x32_bf16 v[68:71], v[204:207], v[180:183], v[68:71]
    ds_read_b64_tr_b16 v[230:231], v11 offset:45568
    v_mfma_f32_16x16x32_bf16 v[68:71], v[200:203], v[176:179], v[68:71]
    v_mfma_f32_16x16x32_bf16 v[72:75], v[200:203], v[184:187], v[72:75]
    v_mfma_f32_16x16x32_bf16 v[72:75], v[204:207], v[188:191], v[72:75]
    v_mfma_f32_16x16x32_bf16 v[76:79], v[204:207], v[196:199], v[76:79]
    v_mfma_f32_16x16x32_bf16 v[76:79], v[200:203], v[192:195], v[76:79]
    s_waitcnt lgkmcnt(8)
    v_mfma_f32_16x16x32_bf16 v[92:95], v[208:211], v[192:195], v[92:95]
    v_mfma_f32_16x16x32_bf16 v[92:95], v[212:215], v[196:199], v[92:95]
    v_mfma_f32_16x16x32_bf16 v[88:91], v[212:215], v[188:191], v[88:91]
    v_mfma_f32_16x16x32_bf16 v[88:91], v[208:211], v[184:187], v[88:91]
    v_mfma_f32_16x16x32_bf16 v[84:87], v[208:211], v[176:179], v[84:87]
    v_mfma_f32_16x16x32_bf16 v[84:87], v[212:215], v[180:183], v[84:87]
    v_mfma_f32_16x16x32_bf16 v[80:83], v[212:215], v[172:175], v[80:83]
    v_mfma_f32_16x16x32_bf16 v[80:83], v[208:211], v[168:171], v[80:83]
    s_waitcnt lgkmcnt(0)
    s_barrier
    ds_read_b128 v[128:131], v4 offset:0
    v_mfma_f32_16x16x32_bf16 v[96:99], v[216:219], v[168:171], v[96:99]
    ds_read_b64_tr_b16 v[200:201], v8 offset:0
    v_mfma_f32_16x16x32_bf16 v[96:99], v[220:223], v[172:175], v[96:99]
    ds_read_b64_tr_b16 v[202:203], v8 offset:512
    v_mfma_f32_16x16x32_bf16 v[100:103], v[220:223], v[180:183], v[100:103]
    ds_read_b128 v[132:135], v5 offset:0
    v_mfma_f32_16x16x32_bf16 v[100:103], v[216:219], v[176:179], v[100:103]
    ds_read_b64_tr_b16 v[204:205], v8 offset:8192
    v_mfma_f32_16x16x32_bf16 v[104:107], v[216:219], v[184:187], v[104:107]
    ds_read_b64_tr_b16 v[206:207], v8 offset:8704
    v_mfma_f32_16x16x32_bf16 v[104:107], v[220:223], v[188:191], v[104:107]
    ds_read_b128 v[140:143], v5 offset:2048
    v_mfma_f32_16x16x32_bf16 v[108:111], v[220:223], v[196:199], v[108:111]
    ds_read_b128 v[136:139], v4 offset:2048
    v_mfma_f32_16x16x32_bf16 v[108:111], v[216:219], v[192:195], v[108:111]
    ds_read_b128 v[144:147], v4 offset:4096
    v_mfma_f32_16x16x32_bf16 v[124:127], v[224:227], v[192:195], v[124:127]
    ds_read_b128 v[148:151], v5 offset:4096
    v_mfma_f32_16x16x32_bf16 v[124:127], v[228:231], v[196:199], v[124:127]
    ds_read_b128 v[156:159], v5 offset:6144
    v_mfma_f32_16x16x32_bf16 v[120:123], v[228:231], v[188:191], v[120:123]
    ds_read_b128 v[152:155], v4 offset:6144
    v_mfma_f32_16x16x32_bf16 v[120:123], v[224:227], v[184:187], v[120:123]
    ds_read_b64_tr_b16 v[208:209], v9 offset:0
    v_mfma_f32_16x16x32_bf16 v[116:119], v[224:227], v[176:179], v[116:119]
    ds_read_b64_tr_b16 v[210:211], v9 offset:512
    v_mfma_f32_16x16x32_bf16 v[116:119], v[228:231], v[180:183], v[116:119]
    ds_read_b64_tr_b16 v[212:213], v9 offset:8192
    v_mfma_f32_16x16x32_bf16 v[112:115], v[228:231], v[172:175], v[112:115]
    s_waitcnt lgkmcnt(13)
    ds_read_b64_tr_b16 v[214:215], v9 offset:8704
    v_mfma_f32_16x16x32_bf16 v[112:115], v[224:227], v[168:171], v[112:115]
    ds_read_b64_tr_b16 v[216:217], v8 offset:2048
    s_waitcnt lgkmcnt(9)
    v_mfma_f32_16x16x32_bf16 v[32:35], v[200:203], v[128:131], v[32:35]
    ds_read_b64_tr_b16 v[218:219], v8 offset:2560
    v_mfma_f32_16x16x32_bf16 v[32:35], v[204:207], v[132:135], v[32:35]
    ds_read_b64_tr_b16 v[220:221], v8 offset:10240
    v_mfma_f32_16x16x32_bf16 v[36:39], v[204:207], v[140:143], v[36:39]
    ds_read_b64_tr_b16 v[222:223], v8 offset:10752
    v_mfma_f32_16x16x32_bf16 v[36:39], v[200:203], v[136:139], v[36:39]
    ds_read_b64_tr_b16 v[224:225], v9 offset:2048
    s_waitcnt lgkmcnt(9)
    v_mfma_f32_16x16x32_bf16 v[40:43], v[200:203], v[144:147], v[40:43]
    ds_read_b64_tr_b16 v[226:227], v9 offset:2560
    v_mfma_f32_16x16x32_bf16 v[40:43], v[204:207], v[148:151], v[40:43]
    ds_read_b64_tr_b16 v[228:229], v9 offset:10240
    v_mfma_f32_16x16x32_bf16 v[44:47], v[204:207], v[156:159], v[44:47]
    ds_read_b64_tr_b16 v[230:231], v9 offset:10752
    v_mfma_f32_16x16x32_bf16 v[44:47], v[200:203], v[152:155], v[44:47]
    ds_read_b64_tr_b16 v[200:201], v12 offset:0
    s_waitcnt lgkmcnt(9)
    v_mfma_f32_16x16x32_bf16 v[60:63], v[208:211], v[152:155], v[60:63]
    ds_read_b64_tr_b16 v[202:203], v12 offset:512
    v_mfma_f32_16x16x32_bf16 v[60:63], v[212:215], v[156:159], v[60:63]
    ds_read_b64_tr_b16 v[204:205], v12 offset:4096
    v_mfma_f32_16x16x32_bf16 v[56:59], v[212:215], v[148:151], v[56:59]
    ds_read_b64_tr_b16 v[206:207], v12 offset:4608
    v_mfma_f32_16x16x32_bf16 v[56:59], v[208:211], v[144:147], v[56:59]
    v_mfma_f32_16x16x32_bf16 v[52:55], v[208:211], v[136:139], v[52:55]
    v_mfma_f32_16x16x32_bf16 v[52:55], v[212:215], v[140:143], v[52:55]
    v_mfma_f32_16x16x32_bf16 v[48:51], v[212:215], v[132:135], v[48:51]
    v_mfma_f32_16x16x32_bf16 v[48:51], v[208:211], v[128:131], v[48:51]
    ds_read_b64_tr_b16 v[208:209], v13 offset:0
    s_waitcnt lgkmcnt(9)
    v_mfma_f32_16x16x32_bf16 v[64:67], v[216:219], v[128:131], v[64:67]
    ds_read_b64_tr_b16 v[210:211], v13 offset:512
    v_mfma_f32_16x16x32_bf16 v[64:67], v[220:223], v[132:135], v[64:67]
    ds_read_b64_tr_b16 v[212:213], v13 offset:4096
    v_mfma_f32_16x16x32_bf16 v[68:71], v[220:223], v[140:143], v[68:71]
    ds_read_b64_tr_b16 v[214:215], v13 offset:4608
    v_mfma_f32_16x16x32_bf16 v[68:71], v[216:219], v[136:139], v[68:71]
    v_mfma_f32_16x16x32_bf16 v[72:75], v[216:219], v[144:147], v[72:75]
    v_mfma_f32_16x16x32_bf16 v[72:75], v[220:223], v[148:151], v[72:75]
    v_mfma_f32_16x16x32_bf16 v[76:79], v[220:223], v[156:159], v[76:79]
    v_mfma_f32_16x16x32_bf16 v[76:79], v[216:219], v[152:155], v[76:79]
    s_waitcnt lgkmcnt(8)
    v_mfma_f32_16x16x32_bf16 v[92:95], v[224:227], v[152:155], v[92:95]
    v_mfma_f32_16x16x32_bf16 v[92:95], v[228:231], v[156:159], v[92:95]
    v_mfma_f32_16x16x32_bf16 v[88:91], v[228:231], v[148:151], v[88:91]
    v_mfma_f32_16x16x32_bf16 v[88:91], v[224:227], v[144:147], v[88:91]
    v_mfma_f32_16x16x32_bf16 v[84:87], v[224:227], v[136:139], v[84:87]
    v_mfma_f32_16x16x32_bf16 v[84:87], v[228:231], v[140:143], v[84:87]
    v_mfma_f32_16x16x32_bf16 v[80:83], v[228:231], v[132:135], v[80:83]
    v_mfma_f32_16x16x32_bf16 v[80:83], v[224:227], v[128:131], v[80:83]
    s_waitcnt lgkmcnt(0)
    s_barrier
    ds_read_b128 v[168:171], v4 offset:40960
    v_mfma_f32_16x16x32_bf16 v[96:99], v[200:203], v[128:131], v[96:99]
    ds_read_b64_tr_b16 v[216:217], v8 offset:40960
    v_mfma_f32_16x16x32_bf16 v[96:99], v[204:207], v[132:135], v[96:99]
    ds_read_b64_tr_b16 v[218:219], v8 offset:41472
    v_mfma_f32_16x16x32_bf16 v[100:103], v[204:207], v[140:143], v[100:103]
    ds_read_b128 v[172:175], v5 offset:40960
    v_mfma_f32_16x16x32_bf16 v[100:103], v[200:203], v[136:139], v[100:103]
    ds_read_b64_tr_b16 v[220:221], v8 offset:49152
    v_mfma_f32_16x16x32_bf16 v[104:107], v[200:203], v[144:147], v[104:107]
    ds_read_b64_tr_b16 v[222:223], v8 offset:49664
    v_mfma_f32_16x16x32_bf16 v[104:107], v[204:207], v[148:151], v[104:107]
    ds_read_b128 v[180:183], v5 offset:43008
    v_mfma_f32_16x16x32_bf16 v[108:111], v[204:207], v[156:159], v[108:111]
    ds_read_b128 v[176:179], v4 offset:43008
    v_mfma_f32_16x16x32_bf16 v[108:111], v[200:203], v[152:155], v[108:111]
    ds_read_b128 v[184:187], v4 offset:45056
    v_mfma_f32_16x16x32_bf16 v[124:127], v[208:211], v[152:155], v[124:127]
    ds_read_b128 v[188:191], v5 offset:45056
    v_mfma_f32_16x16x32_bf16 v[124:127], v[212:215], v[156:159], v[124:127]
    ds_read_b128 v[196:199], v5 offset:47104
    v_mfma_f32_16x16x32_bf16 v[120:123], v[212:215], v[148:151], v[120:123]
    ds_read_b128 v[192:195], v4 offset:47104
    v_mfma_f32_16x16x32_bf16 v[120:123], v[208:211], v[144:147], v[120:123]
    ds_read_b64_tr_b16 v[224:225], v9 offset:40960
    v_mfma_f32_16x16x32_bf16 v[116:119], v[208:211], v[136:139], v[116:119]
    ds_read_b64_tr_b16 v[226:227], v9 offset:41472
    v_mfma_f32_16x16x32_bf16 v[116:119], v[212:215], v[140:143], v[116:119]
    ds_read_b64_tr_b16 v[228:229], v9 offset:49152
    v_mfma_f32_16x16x32_bf16 v[112:115], v[212:215], v[132:135], v[112:115]
    s_waitcnt lgkmcnt(13)
    ds_read_b64_tr_b16 v[230:231], v9 offset:49664
    v_mfma_f32_16x16x32_bf16 v[112:115], v[208:211], v[128:131], v[112:115]
    ds_read_b64_tr_b16 v[200:201], v8 offset:43008
    s_sub_u32 s59, s59, 1
    s_cbranch_scc1 L_clast
    s_waitcnt lgkmcnt(9)
    v_mfma_f32_16x16x32_bf16 v[32:35], v[216:219], v[168:171], v[32:35]
    ds_read_b64_tr_b16 v[202:203], v8 offset:43520
    v_mfma_f32_16x16x32_bf16 v[32:35], v[220:223], v[172:175], v[32:35]
    ds_read_b64_tr_b16 v[204:205], v8 offset:51200
    v_mfma_f32_16x16x32_bf16 v[36:39], v[220:223], v[180:183], v[36:39]
    ds_read_b64_tr_b16 v[206:207], v8 offset:51712
    v_mfma_f32_16x16x32_bf16 v[36:39], v[216:219], v[176:179], v[36:39]
    ds_read_b64_tr_b16 v[208:209], v9 offset:43008
    s_waitcnt lgkmcnt(9)
    v_mfma_f32_16x16x32_bf16 v[40:43], v[216:219], v[184:187], v[40:43]
    ds_read_b64_tr_b16 v[210:211], v9 offset:43520
    v_mfma_f32_16x16x32_bf16 v[40:43], v[220:223], v[188:191], v[40:43]
    ds_read_b64_tr_b16 v[212:213], v9 offset:51200
    v_mfma_f32_16x16x32_bf16 v[44:47], v[220:223], v[196:199], v[44:47]
    ds_read_b64_tr_b16 v[214:215], v9 offset:51712
    v_mfma_f32_16x16x32_bf16 v[44:47], v[216:219], v[192:195], v[44:47]
    ds_read_b64_tr_b16 v[216:217], v12 offset:40960
    s_waitcnt lgkmcnt(9)
    v_mfma_f32_16x16x32_bf16 v[60:63], v[224:227], v[192:195], v[60:63]
    ds_read_b64_tr_b16 v[218:219], v12 offset:41472
    v_mfma_f32_16x16x32_bf16 v[60:63], v[228:231], v[196:199], v[60:63]
    ds_read_b64_tr_b16 v[220:221], v12 offset:45056
    v_mfma_f32_16x16x32_bf16 v[56:59], v[228:231], v[188:191], v[56:59]
    ds_read_b64_tr_b16 v[222:223], v12 offset:45568
    v_mfma_f32_16x16x32_bf16 v[56:59], v[224:227], v[184:187], v[56:59]
    v_mfma_f32_16x16x32_bf16 v[52:55], v[224:227], v[176:179], v[52:55]
    v_mfma_f32_16x16x32_bf16 v[52:55], v[228:231], v[180:183], v[52:55]
    v_mfma_f32_16x16x32_bf16 v[48:51], v[228:231], v[172:175], v[48:51]
    v_mfma_f32_16x16x32_bf16 v[48:51], v[224:227], v[168:171], v[48:51]
    ds_read_b64_tr_b16 v[224:225], v13 offset:40960
    s_waitcnt lgkmcnt(9)
    v_mfma_f32_16x16x32_bf16 v[64:67], v[200:203], v[168:171], v[64:67]
    ds_read_b64_tr_b16 v[226:227], v13 offset:41472
    v_mfma_f32_16x16x32_bf16 v[64:67], v[204:207], v[172:175], v[64:67]
    ds_read_b64_tr_b16 v[228:229], v13 offset:45056
    v_mfma_f32_16x16x32_bf16 v[68:71], v[204:207], v[180:183], v[68:71]
    ds_read_b64_tr_b16 v[230:231], v13 offset:45568
    v_mfma_f32_16x16x32_bf16 v[68:71], v[200:203], v[176:179], v[68:71]
    v_mfma_f32_16x16x32_bf16 v[72:75], v[200:203], v[184:187], v[72:75]
    v_mfma_f32_16x16x32_bf16 v[72:75], v[204:207], v[188:191], v[72:75]
    v_mfma_f32_16x16x32_bf16 v[76:79], v[204:207], v[196:199], v[76:79]
    v_mfma_f32_16x16x32_bf16 v[76:79], v[200:203], v[192:195], v[76:79]
    s_waitcnt lgkmcnt(8)
    v_mfma_f32_16x16x32_bf16 v[92:95], v[208:211], v[192:195], v[92:95]
    v_mfma_f32_16x16x32_bf16 v[92:95], v[212:215], v[196:199], v[92:95]
    v_mfma_f32_16x16x32_bf16 v[88:91], v[212:215], v[188:191], v[88:91]
    v_mfma_f32_16x16x32_bf16 v[88:91], v[208:211], v[184:187], v[88:91]
    v_mfma_f32_16x16x32_bf16 v[84:87], v[208:211], v[176:179], v[84:87]
    v_mfma_f32_16x16x32_bf16 v[84:87], v[212:215], v[180:183], v[84:87]
    v_mfma_f32_16x16x32_bf16 v[80:83], v[212:215], v[172:175], v[80:83]
    v_mfma_f32_16x16x32_bf16 v[80:83], v[208:211], v[168:171], v[80:83]
    s_waitcnt lgkmcnt(0)
    s_barrier
    ds_read_b128 v[128:131], v2 offset:0
    v_mfma_f32_16x16x32_bf16 v[96:99], v[216:219], v[168:171], v[96:99]
    ds_read_b64_tr_b16 v[200:201], v6 offset:0
    v_mfma_f32_16x16x32_bf16 v[96:99], v[220:223], v[172:175], v[96:99]
    ds_read_b64_tr_b16 v[202:203], v6 offset:512
    v_mfma_f32_16x16x32_bf16 v[100:103], v[220:223], v[180:183], v[100:103]
    ds_read_b128 v[132:135], v3 offset:0
    v_mfma_f32_16x16x32_bf16 v[100:103], v[216:219], v[176:179], v[100:103]
    ds_read_b64_tr_b16 v[204:205], v6 offset:8192
    v_mfma_f32_16x16x32_bf16 v[104:107], v[216:219], v[184:187], v[104:107]
    ds_read_b64_tr_b16 v[206:207], v6 offset:8704
    v_mfma_f32_16x16x32_bf16 v[104:107], v[220:223], v[188:191], v[104:107]
    ds_read_b128 v[140:143], v3 offset:2048
    v_mfma_f32_16x16x32_bf16 v[108:111], v[220:223], v[196:199], v[108:111]
    ds_read_b128 v[136:139], v2 offset:2048
    v_mfma_f32_16x16x32_bf16 v[108:111], v[216:219], v[192:195], v[108:111]
    ds_read_b128 v[144:147], v2 offset:4096
    v_mfma_f32_16x16x32_bf16 v[124:127], v[224:227], v[192:195], v[124:127]
    ds_read_b128 v[148:151], v3 offset:4096
    v_mfma_f32_16x16x32_bf16 v[124:127], v[228:231], v[196:199], v[124:127]
    ds_read_b128 v[156:159], v3 offset:6144
    v_mfma_f32_16x16x32_bf16 v[120:123], v[228:231], v[188:191], v[120:123]
    ds_read_b128 v[152:155], v2 offset:6144
    v_mfma_f32_16x16x32_bf16 v[120:123], v[224:227], v[184:187], v[120:123]
    ds_read_b64_tr_b16 v[208:209], v7 offset:0
    v_mfma_f32_16x16x32_bf16 v[116:119], v[224:227], v[176:179], v[116:119]
    ds_read_b64_tr_b16 v[210:211], v7 offset:512
    v_mfma_f32_16x16x32_bf16 v[116:119], v[228:231], v[180:183], v[116:119]
    ds_read_b64_tr_b16 v[212:213], v7 offset:8192
    v_mfma_f32_16x16x32_bf16 v[112:115], v[228:231], v[172:175], v[112:115]
    s_waitcnt lgkmcnt(13)
    ds_read_b64_tr_b16 v[214:215], v7 offset:8704
    v_mfma_f32_16x16x32_bf16 v[112:115], v[224:227], v[168:171], v[112:115]
    ds_read_b64_tr_b16 v[216:217], v6 offset:2048
    s_branch L_c1
.p2align 3
L_clast:
    s_waitcnt lgkmcnt(11)
    v_mfma_f32_16x16x32_bf16 v[32:35], v[216:219], v[168:171], v[32:35]
    ds_read_b64_tr_b16 v[202:203], v8 offset:43520
    s_mov_b32 s18, 0x3fb8aa3b
    s_mov_b32 s19, 0x3fb8aa3b
    v_mfma_f32_16x16x32_bf16 v[32:35], v[220:223], v[172:175], v[32:35]
    ds_read_b64_tr_b16 v[204:205], v8 offset:51200
    s_mov_b32 s40, s16
    s_and_b32 s41, s17, 0xffff
    s_waitcnt lgkmcnt(3)
    v_mfma_f32_16x16x32_bf16 v[48:51], v[228:231], v[172:175], v[48:51]
    ds_read_b64_tr_b16 v[206:207], v8 offset:51712
    s_mov_b32 s42, 0x10000000
    s_mov_b32 s43, 0x20000
    v_mfma_f32_16x16x32_bf16 v[48:51], v[224:227], v[168:171], v[48:51]
    ds_read_b64_tr_b16 v[144:145], v9 offset:43008
    s_mov_b32 s36, s12
    s_and_b32 s37, s13, 0xffff
    v_mfma_f32_16x16x32_bf16 v[52:55], v[224:227], v[176:179], v[52:55]
    ds_read_b64_tr_b16 v[146:147], v9 offset:43520
    s_mov_b32 s38, 0x400000
    s_mov_b32 s39, 0x20000
    v_mfma_f32_16x16x32_bf16 v[52:55], v[228:231], v[180:183], v[52:55]
    ds_read_b64_tr_b16 v[148:149], v9 offset:51200
    v_bfe_u32 v28, v1, 1, 2
    v_xor_b32 v28, v28, v27
    v_mfma_f32_16x16x32_bf16 v[36:39], v[220:223], v[180:183], v[36:39]
    ds_read_b64_tr_b16 v[150:151], v9 offset:51712
    v_cvt_pk_bf16_f32 v128, v32, v33
    v_cvt_pk_bf16_f32 v129, v34, v35
    v_mfma_f32_16x16x32_bf16 v[36:39], v[216:219], v[176:179], v[36:39]
    ds_read_b64_tr_b16 v[152:153], v12 offset:40960
    v_cvt_pk_bf16_f32 v130, v48, v49
    v_cvt_pk_bf16_f32 v131, v50, v51
    v_mfma_f32_16x16x32_bf16 v[40:43], v[216:219], v[184:187], v[40:43]
    ds_read_b64_tr_b16 v[154:155], v12 offset:41472
    v_lshlrev_b32 v28, 4, v28
    v_lshl_add_u32 v28, v26, 6, v28
    v_mfma_f32_16x16x32_bf16 v[40:43], v[220:223], v[188:191], v[40:43]
    ds_read_b64_tr_b16 v[156:157], v12 offset:45056
    s_lshl1_add_u32 s54, s60, s61
    s_lshl_b32 s54, s54, 12
    v_mfma_f32_16x16x32_bf16 v[56:59], v[228:231], v[188:191], v[56:59]
    ds_read_b64_tr_b16 v[158:159], v12 offset:45568
    v_cvt_pk_bf16_f32 v134, v52, v53
    v_cvt_pk_bf16_f32 v135, v54, v55
    v_mfma_f32_16x16x32_bf16 v[56:59], v[224:227], v[184:187], v[56:59]
    ds_read_b64_tr_b16 v[160:161], v13 offset:40960
    v_cvt_pk_bf16_f32 v132, v36, v37
    v_cvt_pk_bf16_f32 v133, v38, v39
    v_mfma_f32_16x16x32_bf16 v[208:211], v[14:17], v[128:131], 0
    ds_read_b64_tr_b16 v[162:163], v13 offset:41472
    s_add_u32 s54, s54, 0x24000
    v_add_u32 v23, s54, v28
    v_mfma_f32_16x16x32_bf16 v[212:215], v[18:21], v[128:131], 0
    ds_read_b64_tr_b16 v[164:165], v13 offset:45056
    s_lshl_b32 s54, s62, 13
    s_add_u32 s54, s54, 0x1c000
    v_mfma_f32_16x16x32_bf16 v[60:63], v[224:227], v[192:195], v[60:63]
    s_waitcnt lgkmcnt(13)
    ds_read_b64_tr_b16 v[166:167], v13 offset:45568
    v_add_u32 v22, s54, v28
    v_mfma_f32_16x16x32_bf16 v[60:63], v[228:231], v[196:199], v[60:63]
    v_cvt_pk_bf16_f32 v136, v40, v41
    v_cvt_pk_bf16_f32 v137, v42, v43
    v_mfma_f32_16x16x32_bf16 v[44:47], v[220:223], v[196:199], v[44:47]
    v_cvt_pk_bf16_f32 v138, v56, v57
    v_cvt_pk_bf16_f32 v139, v58, v59
    v_mfma_f32_16x16x32_bf16 v[44:47], v[216:219], v[192:195], v[44:47]
    v_mfma_f32_16x16x32_bf16 v[216:219], v[14:17], v[132:135], 0
    v_max3_f32 v240, v208, v209, v210
    v_max3_f32 v4, -v208, -v209, -v210
    v_mfma_f32_16x16x32_bf16 v[220:223], v[18:21], v[132:135], 0
    v_max3_f32 v240, v240, v211, v212
    v_max3_f32 v4, v4, -v211, -v212
    v_mfma_f32_16x16x32_bf16 v[224:227], v[14:17], v[136:139], 0
    v_cvt_pk_bf16_f32 v142, v60, v61
    v_cvt_pk_bf16_f32 v143, v62, v63
    v_max3_f32 v240, v240, v213, v214
    v_mfma_f32_16x16x32_bf16 v[228:231], v[18:21], v[136:139], 0
    v_max3_f32 v4, v4, -v213, -v214
    v_max_f32_e64 v240, v240, v215
    v_max_f32_e64 v4, v4, -v215
    s_waitcnt lgkmcnt(0)
    v_mfma_f32_16x16x32_bf16 v[64:67], v[200:203], v[168:171], v[64:67]
    v_cvt_pk_bf16_f32 v140, v44, v45
    v_cvt_pk_bf16_f32 v141, v46, v47
    v_mfma_f32_16x16x32_bf16 v[64:67], v[204:207], v[172:175], v[64:67]
    v_max3_f32 v242, v216, v217, v218
    v_max3_f32 v6, -v216, -v217, -v218
    v_mfma_f32_16x16x32_bf16 v[232:235], v[14:17], v[140:143], 0
    v_max3_f32 v242, v242, v219, v220
    v_max3_f32 v6, v6, -v219, -v220
    v_max3_f32 v242, v242, v221, v222
    v_mfma_f32_16x16x32_bf16 v[236:239], v[18:21], v[140:143], 0
    v_max3_f32 v6, v6, -v221, -v222
    v_max_f32_e64 v242, v242, v223
    v_max_f32_e64 v6, v6, -v223
    v_mfma_f32_16x16x32_bf16 v[68:71], v[204:207], v[180:183], v[68:71]
    v_max3_f32 v244, v224, v225, v226
    v_max3_f32 v8, -v224, -v225, -v226
    v_max3_f32 v244, v244, v227, v228
    v_mfma_f32_16x16x32_bf16 v[68:71], v[200:203], v[176:179], v[68:71]
    v_max3_f32 v8, v8, -v227, -v228
    v_max3_f32 v244, v244, v229, v230
    v_max3_f32 v8, v8, -v229, -v230
    v_mfma_f32_16x16x32_bf16 v[72:75], v[200:203], v[184:187], v[72:75]
    v_max_f32_e64 v244, v244, v231
    v_max_f32_e64 v8, v8, -v231
    v_max3_f32 v246, v232, v233, v234
    v_mfma_f32_16x16x32_bf16 v[72:75], v[204:207], v[188:191], v[72:75]
    v_max3_f32 v12, -v232, -v233, -v234
    v_max3_f32 v246, v246, v235, v236
    v_max3_f32 v12, v12, -v235, -v236
    v_mfma_f32_16x16x32_bf16 v[76:79], v[204:207], v[196:199], v[76:79]
    v_max3_f32 v246, v246, v237, v238
    v_max3_f32 v12, v12, -v237, -v238
    v_max_f32_e64 v246, v246, v239
    v_mfma_f32_16x16x32_bf16 v[76:79], v[200:203], v[192:195], v[76:79]
    v_max_f32_e64 v12, v12, -v239
    v_permlane32_swap_b32 v240, v4
    v_permlane32_swap_b32 v242, v6
    v_mfma_f32_16x16x32_bf16 v[92:95], v[144:147], v[192:195], v[92:95]
    v_permlane32_swap_b32 v244, v8
    v_permlane32_swap_b32 v246, v12
    v_max_f32 v240, v240, v4
    v_mfma_f32_16x16x32_bf16 v[92:95], v[148:151], v[196:199], v[92:95]
    v_max_f32 v242, v242, v6
    v_max_f32 v244, v244, v8
    v_max_f32 v246, v246, v12
    v_mfma_f32_16x16x32_bf16 v[88:91], v[148:151], v[188:191], v[88:91]
    v_permlane16_swap_b32 v240, v242
    v_permlane16_swap_b32 v244, v246
    v_max_f32 v248, v240, v242
    v_mfma_f32_16x16x32_bf16 v[88:91], v[144:147], v[184:187], v[88:91]
    v_max_f32 v249, v244, v246
    v_mul_f32 v240, 0xbfb8aa3b, v248
    v_mul_f32 v242, 0xbfb8aa3b, v248
    v_mfma_f32_16x16x32_bf16 v[84:87], v[144:147], v[176:179], v[84:87]
    v_mul_f32 v244, 0xbfb8aa3b, v249
    v_mul_f32 v246, 0xbfb8aa3b, v249
    v_permlane16_swap_b32 v240, v242
    v_mfma_f32_16x16x32_bf16 v[84:87], v[148:151], v[180:183], v[84:87]
    v_permlane16_swap_b32 v244, v246
    v_mov_b32 v4, v240
    v_mov_b32 v6, v242
    v_mfma_f32_16x16x32_bf16 v[80:83], v[148:151], v[172:175], v[80:83]
    v_mov_b32 v8, v244
    v_mov_b32 v12, v246
    v_permlane32_swap_b32 v240, v4
    v_mfma_f32_16x16x32_bf16 v[80:83], v[144:147], v[168:171], v[80:83]
    v_permlane32_swap_b32 v242, v6
    v_permlane32_swap_b32 v244, v8
    v_permlane32_swap_b32 v246, v12
    v_pk_fma_f32 v[32:33], v[208:209], s[18:19], v[240:241] op_sel_hi:[1,1,0]
    v_pk_fma_f32 v[40:41], v[208:209], s[18:19], v[4:5] op_sel_hi:[1,1,0] neg_lo:[1,0,0] neg_hi:[1,0,0]
    s_barrier
    v_pk_fma_f32 v[34:35], v[210:211], s[18:19], v[240:241] op_sel_hi:[1,1,0]
    v_pk_fma_f32 v[42:43], v[210:211], s[18:19], v[4:5] op_sel_hi:[1,1,0] neg_lo:[1,0,0] neg_hi:[1,0,0]
    v_pk_fma_f32 v[36:37], v[212:213], s[18:19], v[240:241] op_sel_hi:[1,1,0]
    v_pk_fma_f32 v[44:45], v[212:213], s[18:19], v[4:5] op_sel_hi:[1,1,0] neg_lo:[1,0,0] neg_hi:[1,0,0]
    v_pk_fma_f32 v[38:39], v[214:215], s[18:19], v[240:241] op_sel_hi:[1,1,0]
    v_pk_fma_f32 v[46:47], v[214:215], s[18:19], v[4:5] op_sel_hi:[1,1,0] neg_lo:[1,0,0] neg_hi:[1,0,0]
    v_pk_fma_f32 v[48:49], v[216:217], s[18:19], v[242:243] op_sel_hi:[1,1,0]
    v_pk_fma_f32 v[56:57], v[216:217], s[18:19], v[6:7] op_sel_hi:[1,1,0] neg_lo:[1,0,0] neg_hi:[1,0,0]
    v_pk_fma_f32 v[50:51], v[218:219], s[18:19], v[242:243] op_sel_hi:[1,1,0]
    v_pk_fma_f32 v[58:59], v[218:219], s[18:19], v[6:7] op_sel_hi:[1,1,0] neg_lo:[1,0,0] neg_hi:[1,0,0]
    v_pk_fma_f32 v[52:53], v[220:221], s[18:19], v[242:243] op_sel_hi:[1,1,0]
    v_pk_fma_f32 v[60:61], v[220:221], s[18:19], v[6:7] op_sel_hi:[1,1,0] neg_lo:[1,0,0] neg_hi:[1,0,0]
    v_pk_fma_f32 v[54:55], v[222:223], s[18:19], v[242:243] op_sel_hi:[1,1,0]
    v_pk_fma_f32 v[62:63], v[222:223], s[18:19], v[6:7] op_sel_hi:[1,1,0] neg_lo:[1,0,0] neg_hi:[1,0,0]
    v_cvt_pk_bf16_f32 v140, v76, v77
    v_cvt_pk_bf16_f32 v141, v78, v79
    v_cvt_pk_bf16_f32 v142, v92, v93
    v_cvt_pk_bf16_f32 v143, v94, v95
    ds_write_b128 v23, v[140:143] offset:3072
    v_cvt_pk_bf16_f32 v136, v72, v73
    v_cvt_pk_bf16_f32 v137, v74, v75
    v_cvt_pk_bf16_f32 v138, v88, v89
    v_cvt_pk_bf16_f32 v139, v90, v91
    ds_write_b128 v23, v[136:139] offset:2048
    v_cvt_pk_bf16_f32 v132, v68, v69
    v_cvt_pk_bf16_f32 v133, v70, v71
    v_cvt_pk_bf16_f32 v134, v84, v85
    v_cvt_pk_bf16_f32 v135, v86, v87
    ds_write_b128 v23, v[132:135] offset:1024
    v_cvt_pk_bf16_f32 v128, v64, v65
    v_cvt_pk_bf16_f32 v129, v66, v67
    v_cvt_pk_bf16_f32 v130, v80, v81
    v_cvt_pk_bf16_f32 v131, v82, v83
    ds_write_b128 v23, v[128:131] offset:0
    v_pk_fma_f32 v[64:65], v[224:225], s[18:19], v[244:245] op_sel_hi:[1,1,0]
    v_pk_fma_f32 v[72:73], v[224:225], s[18:19], v[8:9] op_sel_hi:[1,1,0] neg_lo:[1,0,0] neg_hi:[1,0,0]
    v_pk_fma_f32 v[66:67], v[226:227], s[18:19], v[244:245] op_sel_hi:[1,1,0]
    v_pk_fma_f32 v[74:75], v[226:227], s[18:19], v[8:9] op_sel_hi:[1,1,0] neg_lo:[1,0,0] neg_hi:[1,0,0]
    v_pk_fma_f32 v[68:69], v[228:229], s[18:19], v[244:245] op_sel_hi:[1,1,0]
    v_pk_fma_f32 v[76:77], v[228:229], s[18:19], v[8:9] op_sel_hi:[1,1,0] neg_lo:[1,0,0] neg_hi:[1,0,0]
    v_pk_fma_f32 v[70:71], v[230:231], s[18:19], v[244:245] op_sel_hi:[1,1,0]
    v_pk_fma_f32 v[78:79], v[230:231], s[18:19], v[8:9] op_sel_hi:[1,1,0] neg_lo:[1,0,0] neg_hi:[1,0,0]
    v_pk_fma_f32 v[80:81], v[232:233], s[18:19], v[246:247] op_sel_hi:[1,1,0]
    v_pk_fma_f32 v[88:89], v[232:233], s[18:19], v[12:13] op_sel_hi:[1,1,0] neg_lo:[1,0,0] neg_hi:[1,0,0]
    v_pk_fma_f32 v[82:83], v[234:235], s[18:19], v[246:247] op_sel_hi:[1,1,0]
    v_pk_fma_f32 v[90:91], v[234:235], s[18:19], v[12:13] op_sel_hi:[1,1,0] neg_lo:[1,0,0] neg_hi:[1,0,0]
    v_pk_fma_f32 v[84:85], v[236:237], s[18:19], v[246:247] op_sel_hi:[1,1,0]
    v_pk_fma_f32 v[92:93], v[236:237], s[18:19], v[12:13] op_sel_hi:[1,1,0] neg_lo:[1,0,0] neg_hi:[1,0,0]
    v_pk_fma_f32 v[86:87], v[238:239], s[18:19], v[246:247] op_sel_hi:[1,1,0]
    v_pk_fma_f32 v[94:95], v[238:239], s[18:19], v[12:13] op_sel_hi:[1,1,0] neg_lo:[1,0,0] neg_hi:[1,0,0]
    v_mfma_f32_16x16x32_bf16 v[96:99], v[152:155], v[168:171], v[96:99]
    v_exp_f32 v208, v32
    v_exp_f32 v209, v40
    v_exp_f32 v210, v33
    v_exp_f32 v211, v41
    v_mfma_f32_16x16x32_bf16 v[96:99], v[156:159], v[172:175], v[96:99]
    v_exp_f32 v212, v34
    v_exp_f32 v213, v42
    v_exp_f32 v214, v35
    v_exp_f32 v215, v43
    v_mfma_f32_16x16x32_bf16 v[100:103], v[156:159], v[180:183], v[100:103]
    v_exp_f32 v216, v36
    v_exp_f32 v217, v44
    v_exp_f32 v218, v37
    v_exp_f32 v219, v45
    v_mfma_f32_16x16x32_bf16 v[100:103], v[152:155], v[176:179], v[100:103]
    v_exp_f32 v220, v38
    v_exp_f32 v221, v46
    v_exp_f32 v222, v39
    v_exp_f32 v223, v47
    v_mfma_f32_16x16x32_bf16 v[104:107], v[152:155], v[184:187], v[104:107]
    v_exp_f32 v224, v48
    v_exp_f32 v225, v56
    v_exp_f32 v226, v49
    v_exp_f32 v227, v57
    v_mfma_f32_16x16x32_bf16 v[104:107], v[156:159], v[188:191], v[104:107]
    v_exp_f32 v228, v50
    v_exp_f32 v229, v58
    v_exp_f32 v230, v51
    v_exp_f32 v231, v59
    v_mfma_f32_16x16x32_bf16 v[108:111], v[156:159], v[196:199], v[108:111]
    v_exp_f32 v232, v52
    v_exp_f32 v233, v60
    v_exp_f32 v234, v53
    v_exp_f32 v235, v61
    v_mfma_f32_16x16x32_bf16 v[108:111], v[152:155], v[192:195], v[108:111]
    v_exp_f32 v236, v54
    v_exp_f32 v237, v62
    v_exp_f32 v238, v55
    v_exp_f32 v239, v63
    v_mfma_f32_16x16x32_bf16 v[124:127], v[160:163], v[192:195], v[124:127]
    v_exp_f32 v32, v64
    v_exp_f32 v33, v72
    v_exp_f32 v34, v65
    v_exp_f32 v35, v73
    v_mfma_f32_16x16x32_bf16 v[124:127], v[164:167], v[196:199], v[124:127]
    v_exp_f32 v36, v66
    v_exp_f32 v37, v74
    v_exp_f32 v38, v67
    v_exp_f32 v39, v75
    v_mfma_f32_16x16x32_bf16 v[120:123], v[164:167], v[188:191], v[120:123]
    v_exp_f32 v40, v68
    v_exp_f32 v41, v76
    v_exp_f32 v42, v69
    v_exp_f32 v43, v77
    v_mfma_f32_16x16x32_bf16 v[120:123], v[160:163], v[184:187], v[120:123]
    v_exp_f32 v44, v70
    v_exp_f32 v45, v78
    v_exp_f32 v46, v71
    v_exp_f32 v47, v79
    v_mfma_f32_16x16x32_bf16 v[116:119], v[160:163], v[176:179], v[116:119]
    v_exp_f32 v48, v80
    v_exp_f32 v49, v88
    v_exp_f32 v50, v81
    v_exp_f32 v51, v89
    v_mfma_f32_16x16x32_bf16 v[116:119], v[164:167], v[180:183], v[116:119]
    v_exp_f32 v52, v82
    v_exp_f32 v53, v90
    v_exp_f32 v54, v83
    v_exp_f32 v55, v91
    v_mfma_f32_16x16x32_bf16 v[112:115], v[164:167], v[172:175], v[112:115]
    v_exp_f32 v56, v84
    v_exp_f32 v57, v92
    v_exp_f32 v58, v85
    v_exp_f32 v59, v93
    v_mfma_f32_16x16x32_bf16 v[112:115], v[160:163], v[168:171], v[112:115]
    v_exp_f32 v60, v86
    v_exp_f32 v61, v94
    v_exp_f32 v62, v87
    v_exp_f32 v63, v95
    v_pk_add_f32 v[64:65], v[208:209], v[210:211]
    v_pk_add_f32 v[66:67], v[212:213], v[214:215]
    v_pk_add_f32 v[68:69], v[216:217], v[218:219]
    v_pk_add_f32 v[70:71], v[220:221], v[222:223]
    v_pk_add_f32 v[72:73], v[224:225], v[226:227]
    v_pk_add_f32 v[74:75], v[228:229], v[230:231]
    v_pk_add_f32 v[76:77], v[232:233], v[234:235]
    v_pk_add_f32 v[78:79], v[236:237], v[238:239]
    v_pk_add_f32 v[80:81], v[32:33], v[34:35]
    v_pk_add_f32 v[82:83], v[36:37], v[38:39]
    v_pk_add_f32 v[84:85], v[40:41], v[42:43]
    v_pk_add_f32 v[86:87], v[44:45], v[46:47]
    v_pk_add_f32 v[88:89], v[48:49], v[50:51]
    v_pk_add_f32 v[90:91], v[52:53], v[54:55]
    v_pk_add_f32 v[92:93], v[56:57], v[58:59]
    v_pk_add_f32 v[94:95], v[60:61], v[62:63]
    v_pk_add_f32 v[64:65], v[64:65], v[66:67]
    v_pk_add_f32 v[68:69], v[68:69], v[70:71]
    v_pk_add_f32 v[72:73], v[72:73], v[74:75]
    v_pk_add_f32 v[76:77], v[76:77], v[78:79]
    v_pk_add_f32 v[80:81], v[80:81], v[82:83]
    v_pk_add_f32 v[84:85], v[84:85], v[86:87]
    v_pk_add_f32 v[88:89], v[88:89], v[90:91]
    v_pk_add_f32 v[92:93], v[92:93], v[94:95]
    v_pk_add_f32 v[240:241], v[64:65], v[68:69]
    v_pk_add_f32 v[242:243], v[72:73], v[76:77]
    v_pk_add_f32 v[244:245], v[80:81], v[84:85]
    v_pk_add_f32 v[246:247], v[88:89], v[92:93]
    v_permlane32_swap_b32 v240, v241
    v_permlane32_swap_b32 v242, v243
    v_permlane32_swap_b32 v244, v245
    v_permlane32_swap_b32 v246, v247
    v_add_f32 v240, v240, v241
    v_add_f32 v242, v242, v243
    v_add_f32 v244, v244, v245
    v_add_f32 v246, v246, v247
    v_permlane16_swap_b32 v240, v242
    s_nop 0
    v_permlane16_swap_b32 v244, v246
    v_add_f32 v248, v240, v242
    v_add_f32 v249, v244, v246
    v_rcp_f32 v240, v248
    v_rcp_f32 v242, v248
    v_rcp_f32 v244, v249
    v_rcp_f32 v246, v249
    v_permlane16_swap_b32 v240, v242
    s_nop 0
    v_permlane16_swap_b32 v244, v246
    v_mov_b32 v241, v240
    v_mov_b32 v243, v242
    v_mov_b32 v245, v244
    v_mov_b32 v247, v246
    v_permlane32_swap_b32 v240, v241
    v_permlane32_swap_b32 v242, v243
    v_permlane32_swap_b32 v244, v245
    v_permlane32_swap_b32 v246, v247
    v_pk_mul_f32 v[208:209], v[208:209], v[240:241]
    v_pk_mul_f32 v[210:211], v[210:211], v[240:241]
    v_pk_mul_f32 v[212:213], v[212:213], v[240:241]
    v_pk_mul_f32 v[214:215], v[214:215], v[240:241]
    v_pk_mul_f32 v[216:217], v[216:217], v[240:241]
    v_pk_mul_f32 v[218:219], v[218:219], v[240:241]
    v_pk_mul_f32 v[220:221], v[220:221], v[240:241]
    v_pk_mul_f32 v[222:223], v[222:223], v[240:241]
    v_cvt_pk_bf16_f32 v64, v208, v210
    v_cvt_pk_bf16_f32 v65, v212, v214
    v_cvt_pk_bf16_f32 v66, v216, v218
    v_cvt_pk_bf16_f32 v67, v220, v222
    ds_write_b128 v22, v[64:67] offset:0
    v_cvt_pk_bf16_f32 v68, v209, v211
    v_cvt_pk_bf16_f32 v69, v213, v215
    v_cvt_pk_bf16_f32 v70, v217, v219
    v_cvt_pk_bf16_f32 v71, v221, v223
    ds_write_b128 v22, v[68:71] offset:4096
    v_pk_mul_f32 v[224:225], v[224:225], v[242:243]
    v_pk_mul_f32 v[226:227], v[226:227], v[242:243]
    v_pk_mul_f32 v[228:229], v[228:229], v[242:243]
    v_pk_mul_f32 v[230:231], v[230:231], v[242:243]
    v_pk_mul_f32 v[232:233], v[232:233], v[242:243]
    v_pk_mul_f32 v[234:235], v[234:235], v[242:243]
    v_pk_mul_f32 v[236:237], v[236:237], v[242:243]
    v_pk_mul_f32 v[238:239], v[238:239], v[242:243]
    v_cvt_pk_bf16_f32 v72, v224, v226
    v_cvt_pk_bf16_f32 v73, v228, v230
    v_cvt_pk_bf16_f32 v74, v232, v234
    v_cvt_pk_bf16_f32 v75, v236, v238
    ds_write_b128 v22, v[72:75] offset:1024
    v_cvt_pk_bf16_f32 v76, v225, v227
    v_cvt_pk_bf16_f32 v77, v229, v231
    v_cvt_pk_bf16_f32 v78, v233, v235
    v_cvt_pk_bf16_f32 v79, v237, v239
    ds_write_b128 v22, v[76:79] offset:5120
    v_pk_mul_f32 v[32:33], v[32:33], v[244:245]
    v_pk_mul_f32 v[34:35], v[34:35], v[244:245]
    v_pk_mul_f32 v[36:37], v[36:37], v[244:245]
    v_pk_mul_f32 v[38:39], v[38:39], v[244:245]
    v_pk_mul_f32 v[40:41], v[40:41], v[244:245]
    v_pk_mul_f32 v[42:43], v[42:43], v[244:245]
    v_pk_mul_f32 v[44:45], v[44:45], v[244:245]
    v_pk_mul_f32 v[46:47], v[46:47], v[244:245]
    v_cvt_pk_bf16_f32 v80, v32, v34
    v_cvt_pk_bf16_f32 v81, v36, v38
    v_cvt_pk_bf16_f32 v82, v40, v42
    v_cvt_pk_bf16_f32 v83, v44, v46
    ds_write_b128 v22, v[80:83] offset:2048
    v_cvt_pk_bf16_f32 v84, v33, v35
    v_cvt_pk_bf16_f32 v85, v37, v39
    v_cvt_pk_bf16_f32 v86, v41, v43
    v_cvt_pk_bf16_f32 v87, v45, v47
    ds_write_b128 v22, v[84:87] offset:6144
    v_pk_mul_f32 v[48:49], v[48:49], v[246:247]
    v_pk_mul_f32 v[50:51], v[50:51], v[246:247]
    v_pk_mul_f32 v[52:53], v[52:53], v[246:247]
    v_pk_mul_f32 v[54:55], v[54:55], v[246:247]
    v_pk_mul_f32 v[56:57], v[56:57], v[246:247]
    v_pk_mul_f32 v[58:59], v[58:59], v[246:247]
    v_pk_mul_f32 v[60:61], v[60:61], v[246:247]
    v_pk_mul_f32 v[62:63], v[62:63], v[246:247]
    v_cvt_pk_bf16_f32 v88, v48, v50
    v_cvt_pk_bf16_f32 v89, v52, v54
    v_cvt_pk_bf16_f32 v90, v56, v58
    v_cvt_pk_bf16_f32 v91, v60, v62
    ds_write_b128 v22, v[88:91] offset:3072
    v_cvt_pk_bf16_f32 v92, v49, v51
    v_cvt_pk_bf16_f32 v93, v53, v55
    v_cvt_pk_bf16_f32 v94, v57, v59
    v_cvt_pk_bf16_f32 v95, v61, v63
    ds_write_b128 v22, v[92:95] offset:7168
    v_cvt_pk_bf16_f32 v128, v96, v97
    v_cvt_pk_bf16_f32 v129, v98, v99
    v_cvt_pk_bf16_f32 v130, v112, v113
    v_cvt_pk_bf16_f32 v131, v114, v115
    s_waitcnt lgkmcnt(0)
    s_barrier
    v_cvt_pk_bf16_f32 v132, v100, v101
    v_cvt_pk_bf16_f32 v133, v102, v103
    v_cvt_pk_bf16_f32 v134, v116, v117
    v_cvt_pk_bf16_f32 v135, v118, v119
    v_cvt_pk_bf16_f32 v136, v104, v105
    v_cvt_pk_bf16_f32 v137, v106, v107
    v_cvt_pk_bf16_f32 v138, v120, v121
    v_cvt_pk_bf16_f32 v139, v122, v123
    v_cvt_pk_bf16_f32 v140, v108, v109
    v_cvt_pk_bf16_f32 v141, v110, v111
    v_cvt_pk_bf16_f32 v142, v124, v125
    v_cvt_pk_bf16_f32 v143, v126, v127
    v_mfma_f32_16x16x32_bf16 v[208:211], v[14:17], v[128:131], 0
    v_mfma_f32_16x16x32_bf16 v[212:215], v[18:21], v[128:131], 0
    v_mfma_f32_16x16x32_bf16 v[216:219], v[14:17], v[132:135], 0
    v_mfma_f32_16x16x32_bf16 v[220:223], v[18:21], v[132:135], 0
    v_mfma_f32_16x16x32_bf16 v[224:227], v[14:17], v[136:139], 0
    v_mfma_f32_16x16x32_bf16 v[228:231], v[18:21], v[136:139], 0
    v_mfma_f32_16x16x32_bf16 v[232:235], v[14:17], v[140:143], 0
    v_mfma_f32_16x16x32_bf16 v[236:239], v[18:21], v[140:143], 0
    s_nop 0
    v_max3_f32 v240, v208, v209, v210
    v_max3_f32 v4, -v208, -v209, -v210
    v_max3_f32 v240, v240, v211, v212
    v_max3_f32 v4, v4, -v211, -v212
    v_max3_f32 v240, v240, v213, v214
    v_max3_f32 v4, v4, -v213, -v214
    v_max_f32_e64 v240, v240, v215
    v_max_f32_e64 v4, v4, -v215
    v_max3_f32 v242, v216, v217, v218
    v_max3_f32 v6, -v216, -v217, -v218
    v_max3_f32 v242, v242, v219, v220
    v_max3_f32 v6, v6, -v219, -v220
    v_max3_f32 v242, v242, v221, v222
    v_max3_f32 v6, v6, -v221, -v222
    v_max_f32_e64 v242, v242, v223
    v_max_f32_e64 v6, v6, -v223
    v_max3_f32 v244, v224, v225, v226
    v_max3_f32 v8, -v224, -v225, -v226
    v_max3_f32 v244, v244, v227, v228
    v_max3_f32 v8, v8, -v227, -v228
    v_max3_f32 v244, v244, v229, v230
    v_max3_f32 v8, v8, -v229, -v230
    v_max_f32_e64 v244, v244, v231
    v_max_f32_e64 v8, v8, -v231
    v_max3_f32 v246, v232, v233, v234
    v_max3_f32 v12, -v232, -v233, -v234
    v_max3_f32 v246, v246, v235, v236
    v_max3_f32 v12, v12, -v235, -v236
    v_max3_f32 v246, v246, v237, v238
    v_max3_f32 v12, v12, -v237, -v238
    v_max_f32_e64 v246, v246, v239
    v_max_f32_e64 v12, v12, -v239
    v_permlane32_swap_b32 v240, v4
    v_permlane32_swap_b32 v242, v6
    v_permlane32_swap_b32 v244, v8
    v_permlane32_swap_b32 v246, v12
    v_max_f32 v240, v240, v4
    v_max_f32 v242, v242, v6
    v_max_f32 v244, v244, v8
    v_max_f32 v246, v246, v12
    v_permlane16_swap_b32 v240, v242
    s_nop 0
    v_permlane16_swap_b32 v244, v246
    v_max_f32 v248, v240, v242
    v_max_f32 v249, v244, v246
    v_mul_f32 v240, 0xbfb8aa3b, v248
    v_mul_f32 v242, 0xbfb8aa3b, v248
    v_mul_f32 v244, 0xbfb8aa3b, v249
    v_mul_f32 v246, 0xbfb8aa3b, v249
    v_permlane16_swap_b32 v240, v242
    s_nop 0
    v_permlane16_swap_b32 v244, v246
    v_mov_b32 v4, v240
    v_mov_b32 v6, v242
    v_mov_b32 v8, v244
    v_mov_b32 v12, v246
    v_permlane32_swap_b32 v240, v4
    v_permlane32_swap_b32 v242, v6
    v_permlane32_swap_b32 v244, v8
    v_permlane32_swap_b32 v246, v12
    v_pk_fma_f32 v[144:145], v[208:209], s[18:19], v[240:241] op_sel_hi:[1,1,0]
    v_pk_fma_f32 v[152:153], v[208:209], s[18:19], v[4:5] op_sel_hi:[1,1,0] neg_lo:[1,0,0] neg_hi:[1,0,0]
    v_pk_fma_f32 v[146:147], v[210:211], s[18:19], v[240:241] op_sel_hi:[1,1,0]
    v_pk_fma_f32 v[154:155], v[210:211], s[18:19], v[4:5] op_sel_hi:[1,1,0] neg_lo:[1,0,0] neg_hi:[1,0,0]
    v_pk_fma_f32 v[148:149], v[212:213], s[18:19], v[240:241] op_sel_hi:[1,1,0]
    v_pk_fma_f32 v[156:157], v[212:213], s[18:19], v[4:5] op_sel_hi:[1,1,0] neg_lo:[1,0,0] neg_hi:[1,0,0]
    v_pk_fma_f32 v[150:151], v[214:215], s[18:19], v[240:241] op_sel_hi:[1,1,0]
    v_pk_fma_f32 v[158:159], v[214:215], s[18:19], v[4:5] op_sel_hi:[1,1,0] neg_lo:[1,0,0] neg_hi:[1,0,0]
    v_pk_fma_f32 v[160:161], v[216:217], s[18:19], v[242:243] op_sel_hi:[1,1,0]
    v_pk_fma_f32 v[168:169], v[216:217], s[18:19], v[6:7] op_sel_hi:[1,1,0] neg_lo:[1,0,0] neg_hi:[1,0,0]
    v_pk_fma_f32 v[162:163], v[218:219], s[18:19], v[242:243] op_sel_hi:[1,1,0]
    v_pk_fma_f32 v[170:171], v[218:219], s[18:19], v[6:7] op_sel_hi:[1,1,0] neg_lo:[1,0,0] neg_hi:[1,0,0]
    v_pk_fma_f32 v[164:165], v[220:221], s[18:19], v[242:243] op_sel_hi:[1,1,0]
    v_pk_fma_f32 v[172:173], v[220:221], s[18:19], v[6:7] op_sel_hi:[1,1,0] neg_lo:[1,0,0] neg_hi:[1,0,0]
    v_pk_fma_f32 v[166:167], v[222:223], s[18:19], v[242:243] op_sel_hi:[1,1,0]
    v_pk_fma_f32 v[174:175], v[222:223], s[18:19], v[6:7] op_sel_hi:[1,1,0] neg_lo:[1,0,0] neg_hi:[1,0,0]
    v_pk_fma_f32 v[176:177], v[224:225], s[18:19], v[244:245] op_sel_hi:[1,1,0]
    v_pk_fma_f32 v[184:185], v[224:225], s[18:19], v[8:9] op_sel_hi:[1,1,0] neg_lo:[1,0,0] neg_hi:[1,0,0]
    v_pk_fma_f32 v[178:179], v[226:227], s[18:19], v[244:245] op_sel_hi:[1,1,0]
    v_pk_fma_f32 v[186:187], v[226:227], s[18:19], v[8:9] op_sel_hi:[1,1,0] neg_lo:[1,0,0] neg_hi:[1,0,0]
    v_pk_fma_f32 v[180:181], v[228:229], s[18:19], v[244:245] op_sel_hi:[1,1,0]
    v_pk_fma_f32 v[188:189], v[228:229], s[18:19], v[8:9] op_sel_hi:[1,1,0] neg_lo:[1,0,0] neg_hi:[1,0,0]
    v_pk_fma_f32 v[182:183], v[230:231], s[18:19], v[244:245] op_sel_hi:[1,1,0]
    v_pk_fma_f32 v[190:191], v[230:231], s[18:19], v[8:9] op_sel_hi:[1,1,0] neg_lo:[1,0,0] neg_hi:[1,0,0]
    v_pk_fma_f32 v[192:193], v[232:233], s[18:19], v[246:247] op_sel_hi:[1,1,0]
    v_pk_fma_f32 v[200:201], v[232:233], s[18:19], v[12:13] op_sel_hi:[1,1,0] neg_lo:[1,0,0] neg_hi:[1,0,0]
    v_pk_fma_f32 v[194:195], v[234:235], s[18:19], v[246:247] op_sel_hi:[1,1,0]
    v_pk_fma_f32 v[202:203], v[234:235], s[18:19], v[12:13] op_sel_hi:[1,1,0] neg_lo:[1,0,0] neg_hi:[1,0,0]
    v_pk_fma_f32 v[196:197], v[236:237], s[18:19], v[246:247] op_sel_hi:[1,1,0]
    v_pk_fma_f32 v[204:205], v[236:237], s[18:19], v[12:13] op_sel_hi:[1,1,0] neg_lo:[1,0,0] neg_hi:[1,0,0]
    v_pk_fma_f32 v[198:199], v[238:239], s[18:19], v[246:247] op_sel_hi:[1,1,0]
    v_pk_fma_f32 v[206:207], v[238:239], s[18:19], v[12:13] op_sel_hi:[1,1,0] neg_lo:[1,0,0] neg_hi:[1,0,0]
    v_exp_f32 v208, v144
    v_exp_f32 v209, v152
    v_exp_f32 v210, v145
    v_exp_f32 v211, v153
    v_exp_f32 v212, v146
    v_exp_f32 v213, v154
    v_exp_f32 v214, v147
    v_exp_f32 v215, v155
    v_exp_f32 v216, v148
    v_exp_f32 v217, v156
    v_exp_f32 v218, v149
    v_exp_f32 v219, v157
    v_exp_f32 v220, v150
    v_exp_f32 v221, v158
    v_exp_f32 v222, v151
    v_exp_f32 v223, v159
    v_exp_f32 v224, v160
    v_exp_f32 v225, v168
    v_exp_f32 v226, v161
    v_exp_f32 v227, v169
    v_exp_f32 v228, v162
    v_exp_f32 v229, v170
    v_exp_f32 v230, v163
    v_exp_f32 v231, v171
    v_exp_f32 v232, v164
    v_exp_f32 v233, v172
    v_exp_f32 v234, v165
    v_exp_f32 v235, v173
    v_exp_f32 v236, v166
    v_exp_f32 v237, v174
    v_exp_f32 v238, v167
    v_exp_f32 v239, v175
    v_exp_f32 v144, v176
    v_exp_f32 v145, v184
    v_exp_f32 v146, v177
    v_exp_f32 v147, v185
    v_exp_f32 v148, v178
    v_exp_f32 v149, v186
    v_exp_f32 v150, v179
    v_exp_f32 v151, v187
    v_exp_f32 v152, v180
    v_exp_f32 v153, v188
    v_exp_f32 v154, v181
    v_exp_f32 v155, v189
    v_exp_f32 v156, v182
    v_exp_f32 v157, v190
    v_exp_f32 v158, v183
    v_exp_f32 v159, v191
    v_exp_f32 v160, v192
    v_exp_f32 v161, v200
    v_exp_f32 v162, v193
    v_exp_f32 v163, v201
    v_exp_f32 v164, v194
    v_exp_f32 v165, v202
    v_exp_f32 v166, v195
    v_exp_f32 v167, v203
    v_exp_f32 v168, v196
    v_exp_f32 v169, v204
    v_exp_f32 v170, v197
    v_exp_f32 v171, v205
    v_exp_f32 v172, v198
    v_exp_f32 v173, v206
    v_exp_f32 v174, v199
    v_exp_f32 v175, v207
    v_pk_add_f32 v[176:177], v[208:209], v[210:211]
    v_pk_add_f32 v[178:179], v[212:213], v[214:215]
    v_pk_add_f32 v[180:181], v[216:217], v[218:219]
    v_pk_add_f32 v[182:183], v[220:221], v[222:223]
    v_pk_add_f32 v[184:185], v[224:225], v[226:227]
    v_pk_add_f32 v[186:187], v[228:229], v[230:231]
    v_pk_add_f32 v[188:189], v[232:233], v[234:235]
    v_pk_add_f32 v[190:191], v[236:237], v[238:239]
    v_pk_add_f32 v[192:193], v[144:145], v[146:147]
    v_pk_add_f32 v[194:195], v[148:149], v[150:151]
    v_pk_add_f32 v[196:197], v[152:153], v[154:155]
    v_pk_add_f32 v[198:199], v[156:157], v[158:159]
    v_pk_add_f32 v[200:201], v[160:161], v[162:163]
    v_pk_add_f32 v[202:203], v[164:165], v[166:167]
    v_pk_add_f32 v[204:205], v[168:169], v[170:171]
    v_pk_add_f32 v[206:207], v[172:173], v[174:175]
    v_pk_add_f32 v[176:177], v[176:177], v[178:179]
    v_pk_add_f32 v[180:181], v[180:181], v[182:183]
    v_pk_add_f32 v[184:185], v[184:185], v[186:187]
    v_pk_add_f32 v[188:189], v[188:189], v[190:191]
    v_pk_add_f32 v[192:193], v[192:193], v[194:195]
    v_pk_add_f32 v[196:197], v[196:197], v[198:199]
    v_pk_add_f32 v[200:201], v[200:201], v[202:203]
    v_pk_add_f32 v[204:205], v[204:205], v[206:207]
    v_pk_add_f32 v[240:241], v[176:177], v[180:181]
    v_pk_add_f32 v[242:243], v[184:185], v[188:189]
    v_pk_add_f32 v[244:245], v[192:193], v[196:197]
    v_pk_add_f32 v[246:247], v[200:201], v[204:205]
    v_permlane32_swap_b32 v240, v241
    v_permlane32_swap_b32 v242, v243
    v_permlane32_swap_b32 v244, v245
    v_permlane32_swap_b32 v246, v247
    v_add_f32 v240, v240, v241
    v_add_f32 v242, v242, v243
    v_add_f32 v244, v244, v245
    v_add_f32 v246, v246, v247
    v_permlane16_swap_b32 v240, v242
    s_nop 0
    v_permlane16_swap_b32 v244, v246
    v_add_f32 v248, v240, v242
    v_add_f32 v249, v244, v246
    v_rcp_f32 v240, v248
    v_rcp_f32 v242, v248
    v_rcp_f32 v244, v249
    v_rcp_f32 v246, v249
    v_permlane16_swap_b32 v240, v242
    s_nop 0
    v_permlane16_swap_b32 v244, v246
    v_mov_b32 v241, v240
    v_mov_b32 v243, v242
    v_mov_b32 v245, v244
    v_mov_b32 v247, v246
    v_permlane32_swap_b32 v240, v241
    v_permlane32_swap_b32 v242, v243
    v_permlane32_swap_b32 v244, v245
    v_permlane32_swap_b32 v246, v247
    v_pk_mul_f32 v[208:209], v[208:209], v[240:241]
    v_pk_mul_f32 v[210:211], v[210:211], v[240:241]
    v_pk_mul_f32 v[212:213], v[212:213], v[240:241]
    v_pk_mul_f32 v[214:215], v[214:215], v[240:241]
    v_pk_mul_f32 v[216:217], v[216:217], v[240:241]
    v_pk_mul_f32 v[218:219], v[218:219], v[240:241]
    v_pk_mul_f32 v[220:221], v[220:221], v[240:241]
    v_pk_mul_f32 v[222:223], v[222:223], v[240:241]
    v_cvt_pk_bf16_f32 v32, v208, v210
    v_cvt_pk_bf16_f32 v33, v212, v214
    v_cvt_pk_bf16_f32 v34, v216, v218
    v_cvt_pk_bf16_f32 v35, v220, v222
    v_cvt_pk_bf16_f32 v36, v209, v211
    v_cvt_pk_bf16_f32 v37, v213, v215
    v_cvt_pk_bf16_f32 v38, v217, v219
    v_cvt_pk_bf16_f32 v39, v221, v223
    v_pk_mul_f32 v[224:225], v[224:225], v[242:243]
    v_pk_mul_f32 v[226:227], v[226:227], v[242:243]
    v_pk_mul_f32 v[228:229], v[228:229], v[242:243]
    v_pk_mul_f32 v[230:231], v[230:231], v[242:243]
    v_pk_mul_f32 v[232:233], v[232:233], v[242:243]
    v_pk_mul_f32 v[234:235], v[234:235], v[242:243]
    v_pk_mul_f32 v[236:237], v[236:237], v[242:243]
    v_pk_mul_f32 v[238:239], v[238:239], v[242:243]
    v_cvt_pk_bf16_f32 v40, v224, v226
    v_cvt_pk_bf16_f32 v41, v228, v230
    v_cvt_pk_bf16_f32 v42, v232, v234
    v_cvt_pk_bf16_f32 v43, v236, v238
    v_cvt_pk_bf16_f32 v44, v225, v227
    v_cvt_pk_bf16_f32 v45, v229, v231
    v_cvt_pk_bf16_f32 v46, v233, v235
    v_cvt_pk_bf16_f32 v47, v237, v239
    v_pk_mul_f32 v[144:145], v[144:145], v[244:245]
    v_pk_mul_f32 v[146:147], v[146:147], v[244:245]
    v_pk_mul_f32 v[148:149], v[148:149], v[244:245]
    v_pk_mul_f32 v[150:151], v[150:151], v[244:245]
    v_pk_mul_f32 v[152:153], v[152:153], v[244:245]
    v_pk_mul_f32 v[154:155], v[154:155], v[244:245]
    v_pk_mul_f32 v[156:157], v[156:157], v[244:245]
    v_pk_mul_f32 v[158:159], v[158:159], v[244:245]
    v_cvt_pk_bf16_f32 v48, v144, v146
    v_cvt_pk_bf16_f32 v49, v148, v150
    v_cvt_pk_bf16_f32 v50, v152, v154
    v_cvt_pk_bf16_f32 v51, v156, v158
    v_cvt_pk_bf16_f32 v52, v145, v147
    v_cvt_pk_bf16_f32 v53, v149, v151
    v_cvt_pk_bf16_f32 v54, v153, v155
    v_cvt_pk_bf16_f32 v55, v157, v159
    v_pk_mul_f32 v[160:161], v[160:161], v[246:247]
    v_pk_mul_f32 v[162:163], v[162:163], v[246:247]
    v_pk_mul_f32 v[164:165], v[164:165], v[246:247]
    v_pk_mul_f32 v[166:167], v[166:167], v[246:247]
    v_pk_mul_f32 v[168:169], v[168:169], v[246:247]
    v_pk_mul_f32 v[170:171], v[170:171], v[246:247]
    v_pk_mul_f32 v[172:173], v[172:173], v[246:247]
    v_pk_mul_f32 v[174:175], v[174:175], v[246:247]
    v_cvt_pk_bf16_f32 v56, v160, v162
    v_cvt_pk_bf16_f32 v57, v164, v166
    v_cvt_pk_bf16_f32 v58, v168, v170
    v_cvt_pk_bf16_f32 v59, v172, v174
    v_cvt_pk_bf16_f32 v60, v161, v163
    v_cvt_pk_bf16_f32 v61, v165, v167
    v_cvt_pk_bf16_f32 v62, v169, v171
    v_cvt_pk_bf16_f32 v63, v173, v175
    s_lshl_b32 s52, s60, 13
    s_add_u32 s52, s52, 0x20000
    v_lshlrev_b32 v10, 4, v1
    v_add_u32 v26, s52, v10
    v_and_b32 v27, 48, v1
    v_add_u32 v27, s52, v27
    s_lshl1_add_u32 s52, s48, s61
    s_lshl_b32 s52, s52, 6
    s_add_u32 s52, s52, s49
    s_lshl1_add_u32 s52, s52, s60
    s_lshl_b32 s52, s52, 10
    s_add_u32 s52, s52, 0x400000
    s_add_u32 s53, s52, 0x8000
    s_add_u32 s54, s52, 0x10000
    s_add_u32 s55, s52, 0x18000
    s_lshl1_add_u32 s68, s48, s61
    s_lshl_b32 s68, s68, 6
    s_lshl1_add_u32 s70, s49, s60
    s_add_u32 s68, s68, s70
    s_lshl_b32 s68, s68, 4
    s_add_u32 s68, s68, 0x850000
    v_and_b32 v90, 1, v1
    v_lshrrev_b32 v89, 2, v1
    v_lshl_add_u32 v89, v90, 9, v89
    s_mov_b32 s70, 0x30003
    s_mov_b32 s71, 0x30003
    s_mov_b32 s74, 0x20002
    s_mov_b32 s75, 0x20002
    v_bfe_u32 v93, v1, 2, 1
    v_lshrrev_b32 v92, 4, v1
    v_lshl_add_u32 v92, v93, 2, v92
    v_bfe_u32 v93, v1, 3, 1
    v_lshl_add_u32 v92, v92, 3, v93
    v_and_b32 v93, 3, v1
    v_lshl_add_u32 v92, v92, 2, v93
    v_lshlrev_b32 v92, 3, v92
    s_lshl1_add_u32 s72, s49, s60
    s_lshl_b32 s72, s72, 12
    s_add_u32 s72, s72, 0x820000
    s_mov_b32 s59, 0x10000
    s_barrier
    buffer_load_dwordx2 v[64:65], v92, s[40:43], s72 offen offset:0 sc1
    buffer_load_dwordx2 v[66:67], v92, s[40:43], s72 offen offset:128 sc1
    buffer_load_dwordx2 v[68:69], v92, s[40:43], s72 offen offset:64 sc1
    buffer_load_dwordx2 v[70:71], v92, s[40:43], s72 offen offset:192 sc1
    buffer_load_dwordx2 v[72:73], v92, s[40:43], s72 offen offset:2048 sc1
    buffer_load_dwordx2 v[74:75], v92, s[40:43], s72 offen offset:2176 sc1
    buffer_load_dwordx2 v[76:77], v92, s[40:43], s72 offen offset:2112 sc1
    buffer_load_dwordx2 v[78:79], v92, s[40:43], s72 offen offset:2240 sc1
    ds_read_b128 v[80:83], v27 offset:2048
    ds_read_b128 v[84:87], v27 offset:6144
    ds_read_b32 v88, v27 offset:2112
    s_waitcnt lgkmcnt(0)
    v_mfma_f32_16x16x32_bf16 v[160:163], v[80:83], v[32:35], 0
    v_mfma_f32_16x16x32_bf16 v[164:167], v[80:83], v[40:43], 0
    v_mfma_f32_16x16x32_bf16 v[168:171], v[80:83], v[48:51], 0
    v_mfma_f32_16x16x32_bf16 v[172:175], v[80:83], v[56:59], 0
    v_mfma_f32_16x16x32_bf16 v[160:163], v[84:87], v[36:39], v[160:163]
    v_mfma_f32_16x16x32_bf16 v[164:167], v[84:87], v[44:47], v[164:167]
    v_mfma_f32_16x16x32_bf16 v[168:171], v[84:87], v[52:55], v[168:171]
    v_mfma_f32_16x16x32_bf16 v[172:175], v[84:87], v[60:63], v[172:175]
    v_readfirstlane_b32 s76, v88
    s_nop 3
    v_add_f32 v160, 0x358637bd, v160
    v_add_f32 v164, 0x358637bd, v164
    v_add_f32 v168, 0x358637bd, v168
    v_add_f32 v172, 0x358637bd, v172
    v_rcp_f32 v160, v160
    v_rcp_f32 v164, v164
    v_rcp_f32 v168, v168
    v_rcp_f32 v172, v172
    s_branch L_cf1
L_cf0:
    buffer_load_dwordx2 v[64:65], v92, s[40:43], s72 offen offset:0 sc1
    buffer_load_dwordx2 v[66:67], v92, s[40:43], s72 offen offset:128 sc1
    buffer_load_dwordx2 v[68:69], v92, s[40:43], s72 offen offset:64 sc1
    buffer_load_dwordx2 v[70:71], v92, s[40:43], s72 offen offset:192 sc1
    buffer_load_dwordx2 v[72:73], v92, s[40:43], s72 offen offset:2048 sc1
    buffer_load_dwordx2 v[74:75], v92, s[40:43], s72 offen offset:2176 sc1
    buffer_load_dwordx2 v[76:77], v92, s[40:43], s72 offen offset:2112 sc1
    buffer_load_dwordx2 v[78:79], v92, s[40:43], s72 offen offset:2240 sc1
L_cf1:
    s_waitcnt vmcnt(0)
    v_max3_u32 v26, v64, v65, v66
    v_max3_u32 v27, v67, v68, v69
    v_max3_u32 v26, v26, v70, v71
    v_max3_u32 v27, v27, v72, v73
    v_max3_u32 v26, v26, v74, v75
    v_max3_u32 v27, v27, v76, v77
    v_max3_u32 v26, v26, v78, v79
    v_max_u32 v26, v26, v27
    v_cmp_eq_u32 vcc, -1, v26
    s_cbranch_vccz L_cf2
    s_mov_b64 exec, vcc
    s_sub_u32 s59, s59, 1
    s_cbranch_scc0 L_cf0
L_cf2:
    s_mov_b64 exec, -1
    v_mfma_f32_16x16x32_bf16 v[96:99], v[64:67], v[32:35], 0
    v_mfma_f32_16x16x32_bf16 v[100:103], v[68:71], v[32:35], 0
    v_mfma_f32_16x16x32_bf16 v[96:99], v[72:75], v[36:39], v[96:99]
    v_mfma_f32_16x16x32_bf16 v[100:103], v[76:79], v[36:39], v[100:103]
    v_mfma_f32_16x16x32_bf16 v[104:107], v[64:67], v[40:43], 0
    v_mfma_f32_16x16x32_bf16 v[108:111], v[68:71], v[40:43], 0
    v_mfma_f32_16x16x32_bf16 v[104:107], v[72:75], v[44:47], v[104:107]
    v_mfma_f32_16x16x32_bf16 v[108:111], v[76:79], v[44:47], v[108:111]
    v_mfma_f32_16x16x32_bf16 v[112:115], v[64:67], v[48:51], 0
    s_nop 1
    v_pk_mul_f32 v[96:97], v[96:97], v[160:161] op_sel_hi:[1,0]
    v_pk_mul_f32 v[98:99], v[98:99], v[160:161] op_sel_hi:[1,0]
    v_mfma_f32_16x16x32_bf16 v[116:119], v[68:71], v[48:51], 0
    v_pk_mul_f32 v[100:101], v[100:101], v[160:161] op_sel_hi:[1,0]
    v_pk_mul_f32 v[102:103], v[102:103], v[160:161] op_sel_hi:[1,0]
    v_mfma_f32_16x16x32_bf16 v[112:115], v[72:75], v[52:55], v[112:115]
    v_cvt_pk_bf16_f32 v144, v96, v97
    v_cvt_pk_bf16_f32 v145, v98, v99
    v_mfma_f32_16x16x32_bf16 v[116:119], v[76:79], v[52:55], v[116:119]
    v_cvt_pk_bf16_f32 v146, v100, v101
    v_cvt_pk_bf16_f32 v147, v102, v103
    buffer_store_dwordx4 v[144:147], v10, s[40:43], s52 offen sc1
    v_add3_u32 v90, v144, v145, v146
    v_add_u32 v90, v90, v147
    v_mfma_f32_16x16x32_bf16 v[120:123], v[64:67], v[56:59], 0
    v_pk_mul_f32 v[104:105], v[104:105], v[164:165] op_sel_hi:[1,0]
    v_pk_mul_f32 v[106:107], v[106:107], v[164:165] op_sel_hi:[1,0]
    v_mfma_f32_16x16x32_bf16 v[124:127], v[68:71], v[56:59], 0
    v_pk_mul_f32 v[108:109], v[108:109], v[164:165] op_sel_hi:[1,0]
    v_pk_mul_f32 v[110:111], v[110:111], v[164:165] op_sel_hi:[1,0]
    v_mfma_f32_16x16x32_bf16 v[120:123], v[72:75], v[60:63], v[120:123]
    v_cvt_pk_bf16_f32 v148, v104, v105
    v_cvt_pk_bf16_f32 v149, v106, v107
    v_mfma_f32_16x16x32_bf16 v[124:127], v[76:79], v[60:63], v[124:127]
    v_cvt_pk_bf16_f32 v150, v108, v109
    v_cvt_pk_bf16_f32 v151, v110, v111
    buffer_store_dwordx4 v[148:151], v10, s[40:43], s53 offen sc1
    v_add3_u32 v90, v90, v148, v149
    v_add3_u32 v90, v90, v150, v151
    v_pk_mul_f32 v[112:113], v[112:113], v[168:169] op_sel_hi:[1,0]
    v_pk_mul_f32 v[114:115], v[114:115], v[168:169] op_sel_hi:[1,0]
    v_pk_mul_f32 v[116:117], v[116:117], v[168:169] op_sel_hi:[1,0]
    v_pk_mul_f32 v[118:119], v[118:119], v[168:169] op_sel_hi:[1,0]
    v_cvt_pk_bf16_f32 v152, v112, v113
    v_cvt_pk_bf16_f32 v153, v114, v115
    v_cvt_pk_bf16_f32 v154, v116, v117
    v_cvt_pk_bf16_f32 v155, v118, v119
    buffer_store_dwordx4 v[152:155], v10, s[40:43], s54 offen sc1
    v_add3_u32 v91, v152, v153, v154
    v_add_u32 v91, v91, v155
    v_pk_mul_f32 v[120:121], v[120:121], v[172:173] op_sel_hi:[1,0]
    v_pk_mul_f32 v[122:123], v[122:123], v[172:173] op_sel_hi:[1,0]
    v_pk_mul_f32 v[124:125], v[124:125], v[172:173] op_sel_hi:[1,0]
    v_pk_mul_f32 v[126:127], v[126:127], v[172:173] op_sel_hi:[1,0]
    v_cvt_pk_bf16_f32 v156, v120, v121
    v_cvt_pk_bf16_f32 v157, v122, v123
    v_cvt_pk_bf16_f32 v158, v124, v125
    v_cvt_pk_bf16_f32 v159, v126, v127
    buffer_store_dwordx4 v[156:159], v10, s[40:43], s55 offen sc1
    v_add3_u32 v91, v91, v156, v157
    v_add3_u32 v91, v91, v158, v159
    v_add_u32_dpp v90, v90, v90 row_ror:8 row_mask:0xf bank_mask:0xf
    s_nop 0
    v_add_u32_dpp v91, v91, v91 row_ror:8 row_mask:0xf bank_mask:0xf
    v_add_u32_dpp v90, v90, v90 row_ror:4 row_mask:0xf bank_mask:0xf
    s_nop 0
    v_add_u32_dpp v91, v91, v91 row_ror:4 row_mask:0xf bank_mask:0xf
    v_add_u32_dpp v90, v90, v90 row_ror:2 row_mask:0xf bank_mask:0xf
    s_nop 0
    v_add_u32_dpp v91, v91, v91 row_ror:2 row_mask:0xf bank_mask:0xf
    v_add_u32_dpp v90, v90, v90 row_ror:1 row_mask:0xf bank_mask:0xf
    s_nop 0
    v_add_u32_dpp v91, v91, v91 row_ror:1 row_mask:0xf bank_mask:0xf
    v_cndmask_b32 v90, v90, v91, s[74:75]
    v_sub_u32 v90, s76, v90
    s_mov_b64 exec, s[70:71]
    buffer_store_dword v90, v89, s[40:43], s68 offen sc1
    s_mov_b64 exec, -1
    s_lshl_b32 s76, s76, 1
    v_lshlrev_b32 v26, 4, v1
    s_lshl2_add_u32 s52, s50, s62
    s_lshl_b32 s52, s52, 16
    s_add_u32 s52, s52, 0x8000
    s_lshl_b32 s79, s51, 7
    s_add_u32 s79, s79, s52
    s_add_u32 s52, s52, 0x400000
    v_add_u32 v240, s52, v26
    v_xor_b32 v241, 0x8000, v240
    s_lshl_b32 s52, s3, 12
    s_add_u32 s52, s52, 0x20000
    v_add_u32 v138, s52, v26
    v_xor_b32 v139, 0x4000, v138
    v_lshrrev_b32 v26, 4, v1
    v_bfe_u32 v27, v1, 2, 2
    v_lshl_add_u32 v27, v26, 3, v27
    v_lshlrev_b32 v27, 7, v27
    v_bfe_u32 v28, v1, 3, 2
    v_lshl_add_u32 v27, v28, 5, v27
    v_and_b32 v28, 3, v1
    v_lshl_add_u32 v242, v28, 3, v27
    v_xor_b32 v243, 32, v242
    v_xor_b32 v244, 64, v242
    v_xor_b32 v245, 96, v242
    v_and_b32 v27, 15, v1
    v_lshlrev_b32 v27, 11, v27
    v_and_b32 v28, 1, v26
    v_lshl_add_u32 v27, v28, 5, v27
    v_lshrrev_b32 v28, 1, v26
    v_lshl_add_u32 v140, v28, 4, v27
    s_lshl2_add_u32 s52, s50, s62
    s_lshl_b32 s52, s52, 9
    s_add_u32 s52, s52, 0x850100
    s_or_b32 s53, s49, 1
    s_lshl1_add_u32 s53, s53, 2
    v_add_u32 v27, s53, v1
    v_and_b32 v27, 15, v27
    v_lshl_add_u32 v27, v27, 2, v26
    v_lshl_add_u32 v141, v27, 2, s52
    s_or_b32 s53, s49, 1
    s_add_u32 s53, s53, 1
    s_add_u32 s52, s53, 0
    s_and_b32 s52, s52, 7
    s_add_u32 s52, s52, 8
    s_lshl_b32 s80, s52, 11
    s_sub_u32 s52, s52, s50
    s_and_b32 s52, s52, 15
    s_lshl_b32 s88, s52, 13
    s_add_u32 s52, s53, 1
    s_and_b32 s52, s52, 7
    s_add_u32 s52, s52, 8
    s_lshl_b32 s81, s52, 11
    s_sub_u32 s52, s52, s50
    s_and_b32 s52, s52, 15
    s_lshl_b32 s89, s52, 13
    s_add_u32 s52, s53, 2
    s_and_b32 s52, s52, 7
    s_add_u32 s52, s52, 8
    s_lshl_b32 s82, s52, 11
    s_sub_u32 s52, s52, s50
    s_and_b32 s52, s52, 15
    s_lshl_b32 s90, s52, 13
    s_add_u32 s52, s53, 3
    s_and_b32 s52, s52, 7
    s_add_u32 s52, s52, 8
    s_lshl_b32 s83, s52, 11
    s_sub_u32 s52, s52, s50
    s_and_b32 s52, s52, 15
    s_lshl_b32 s91, s52, 13
    s_add_u32 s52, s53, 4
    s_and_b32 s52, s52, 7
    s_add_u32 s52, s52, 8
    s_lshl_b32 s84, s52, 11
    s_sub_u32 s52, s52, s50
    s_and_b32 s52, s52, 15
    s_lshl_b32 s94, s52, 13
    s_add_u32 s52, s53, 5
    s_and_b32 s52, s52, 7
    s_add_u32 s52, s52, 8
    s_lshl_b32 s85, s52, 11
    s_sub_u32 s52, s52, s50
    s_and_b32 s52, s52, 15
    s_lshl_b32 s95, s52, 13
    s_add_u32 s52, s53, 6
    s_and_b32 s52, s52, 7
    s_add_u32 s52, s52, 8
    s_lshl_b32 s86, s52, 11
    s_sub_u32 s52, s52, s50
    s_and_b32 s52, s52, 15
    s_lshl_b32 s96, s52, 13
    s_add_u32 s52, s53, 7
    s_and_b32 s52, s52, 7
    s_add_u32 s52, s52, 8
    s_lshl_b32 s87, s52, 11
    s_sub_u32 s52, s52, s50
    s_and_b32 s52, s52, 15
    s_lshl_b32 s97, s52, 13
    v_add_u32 v246, s88, v242
    v_add_u32 v247, s88, v243
    v_add_u32 v248, s88, v244
    v_add_u32 v249, s88, v245
L_p3:
    s_barrier
    s_mov_b32 s66, 0x30003
    s_mov_b32 s67, 0x30003
    ds_read_b64_tr_b16 v[64:65], v246 offset:0
    ds_read_b64_tr_b16 v[66:67], v246 offset:512
    ds_read_b64_tr_b16 v[68:69], v246 offset:4096
    ds_read_b64_tr_b16 v[70:71], v246 offset:4608
    ds_read_b64_tr_b16 v[72:73], v247 offset:0
    ds_read_b64_tr_b16 v[74:75], v247 offset:512
    ds_read_b64_tr_b16 v[76:77], v247 offset:4096
    ds_read_b64_tr_b16 v[78:79], v247 offset:4608
    ds_read_b64_tr_b16 v[80:81], v248 offset:0
    ds_read_b64_tr_b16 v[82:83], v248 offset:512
    ds_read_b64_tr_b16 v[84:85], v248 offset:4096
    ds_read_b64_tr_b16 v[86:87], v248 offset:4608
    s_mov_b32 s59, 0x10000
L_r0:
    buffer_load_dword v112, v141, s[40:43], 0 offen sc1
    buffer_load_dwordx4 v[176:179], v240, s[40:43], s80 offen offset:0 sc1
    buffer_load_dwordx4 v[180:183], v241, s[40:43], s80 offen offset:0 sc1
    buffer_load_dwordx4 v[184:187], v240, s[40:43], s80 offen offset:1024 sc1
    buffer_load_dwordx4 v[188:191], v241, s[40:43], s80 offen offset:1024 sc1
    buffer_load_dwordx4 v[192:195], v240, s[40:43], s81 offen offset:0 sc1
    buffer_load_dwordx4 v[196:199], v241, s[40:43], s81 offen offset:0 sc1
    buffer_load_dwordx4 v[200:203], v240, s[40:43], s81 offen offset:1024 sc1
    buffer_load_dwordx4 v[204:207], v241, s[40:43], s81 offen offset:1024 sc1
    s_waitcnt vmcnt(4)
    v_add3_u32 v26, v176, v177, v178
    v_add3_u32 v27, v179, v180, v181
    v_add3_u32 v26, v26, v182, v183
    v_add3_u32 v27, v27, v184, v185
    v_add3_u32 v26, v26, v186, v187
    v_add3_u32 v27, v27, v188, v189
    v_add3_u32 v26, v26, v190, v191
    v_add_u32 v26, v26, v27
    s_nop 1
    v_add_u32_dpp v26, v26, v26 row_ror:8 row_mask:0xf bank_mask:0xf
    s_nop 1
    v_add_u32_dpp v26, v26, v26 row_ror:4 row_mask:0xf bank_mask:0xf
    s_nop 1
    v_add_u32_dpp v26, v26, v26 row_ror:2 row_mask:0xf bank_mask:0xf
    v_add_u32 v26, v26, v112
    s_nop 1
    v_add_u32_dpp v26, v26, v26 quad_perm:[1,0,3,2] row_mask:0xf bank_mask:0xf
    v_cmp_ne_u32 vcc, s76, v26
    s_and_b64 vcc, vcc, s[66:67]
    s_cbranch_vccz L_ok0
    s_sub_u32 s59, s59, 1
    s_waitcnt vmcnt(0)
    s_cbranch_scc0 L_r0
L_ok0:
    s_lshl_b64 s[66:67], s[66:67], 2
    buffer_load_dwordx4 v[208:211], v240, s[40:43], s82 offen offset:0 sc1
    buffer_load_dwordx4 v[212:215], v241, s[40:43], s82 offen offset:0 sc1
    buffer_load_dwordx4 v[216:219], v240, s[40:43], s82 offen offset:1024 sc1
    buffer_load_dwordx4 v[220:223], v241, s[40:43], s82 offen offset:1024 sc1
    s_waitcnt lgkmcnt(8)
    v_mfma_f32_16x16x32_bf16 v[32:35], v[64:67], v[176:179], 0
    ds_read_b64_tr_b16 v[88:89], v249 offset:0
    v_add_u32 v250, s89, v242
    v_mfma_f32_16x16x32_bf16 v[32:35], v[68:71], v[184:187], v[32:35]
    ds_read_b64_tr_b16 v[90:91], v249 offset:512
    v_add_u32 v251, s89, v243
    v_mfma_f32_16x16x32_bf16 v[36:39], v[64:67], v[180:183], 0
    ds_read_b64_tr_b16 v[92:93], v249 offset:4096
    v_add_u32 v252, s89, v244
    v_mfma_f32_16x16x32_bf16 v[36:39], v[68:71], v[188:191], v[36:39]
    ds_read_b64_tr_b16 v[94:95], v249 offset:4608
    v_add_u32 v253, s89, v245
    s_waitcnt lgkmcnt(8)
    v_mfma_f32_16x16x32_bf16 v[40:43], v[72:75], v[176:179], 0
    ds_read_b64_tr_b16 v[96:97], v250 offset:0
    v_mfma_f32_16x16x32_bf16 v[40:43], v[76:79], v[184:187], v[40:43]
    ds_read_b64_tr_b16 v[98:99], v250 offset:512
    v_mfma_f32_16x16x32_bf16 v[44:47], v[72:75], v[180:183], 0
    ds_read_b64_tr_b16 v[100:101], v250 offset:4096
    v_mfma_f32_16x16x32_bf16 v[44:47], v[76:79], v[188:191], v[44:47]
    ds_read_b64_tr_b16 v[102:103], v250 offset:4608
    s_waitcnt lgkmcnt(8)
    v_mfma_f32_16x16x32_bf16 v[48:51], v[80:83], v[176:179], 0
    ds_read_b64_tr_b16 v[104:105], v251 offset:0
    s_waitcnt vmcnt(4)
    v_add3_u32 v26, v192, v193, v194
    v_add3_u32 v27, v195, v196, v197
    v_add3_u32 v26, v26, v198, v199
    v_mfma_f32_16x16x32_bf16 v[48:51], v[84:87], v[184:187], v[48:51]
    ds_read_b64_tr_b16 v[106:107], v251 offset:512
    v_add3_u32 v27, v27, v200, v201
    v_add3_u32 v26, v26, v202, v203
    v_add3_u32 v27, v27, v204, v205
    v_mfma_f32_16x16x32_bf16 v[52:55], v[80:83], v[180:183], 0
    ds_read_b64_tr_b16 v[108:109], v251 offset:4096
    v_add3_u32 v26, v26, v206, v207
    v_add_u32 v26, v26, v27
    v_mfma_f32_16x16x32_bf16 v[52:55], v[84:87], v[188:191], v[52:55]
    ds_read_b64_tr_b16 v[110:111], v251 offset:4608
    v_add_u32_dpp v26, v26, v26 row_ror:8 row_mask:0xf bank_mask:0xf
    s_waitcnt lgkmcnt(8)
    v_mfma_f32_16x16x32_bf16 v[56:59], v[88:91], v[176:179], 0
    ds_read_b64_tr_b16 v[64:65], v252 offset:0
    v_add_u32_dpp v26, v26, v26 row_ror:4 row_mask:0xf bank_mask:0xf
    v_mfma_f32_16x16x32_bf16 v[56:59], v[92:95], v[184:187], v[56:59]
    ds_read_b64_tr_b16 v[66:67], v252 offset:512
    v_add_u32_dpp v26, v26, v26 row_ror:2 row_mask:0xf bank_mask:0xf
    v_add_u32 v26, v26, v112
    v_mfma_f32_16x16x32_bf16 v[60:63], v[88:91], v[180:183], 0
    ds_read_b64_tr_b16 v[68:69], v252 offset:4096
    v_add_u32_dpp v26, v26, v26 quad_perm:[1,0,3,2] row_mask:0xf bank_mask:0xf
    v_cmp_ne_u32 vcc, s76, v26
    v_mfma_f32_16x16x32_bf16 v[60:63], v[92:95], v[188:191], v[60:63]
    ds_read_b64_tr_b16 v[70:71], v252 offset:4608
    s_and_b64 vcc, vcc, s[66:67]
    s_cbranch_vccnz L_rt1
L_ok1:
    s_lshl_b64 s[66:67], s[66:67], 2
    buffer_load_dwordx4 v[224:227], v240, s[40:43], s83 offen offset:0 sc1
    buffer_load_dwordx4 v[228:231], v241, s[40:43], s83 offen offset:0 sc1
    buffer_load_dwordx4 v[232:235], v240, s[40:43], s83 offen offset:1024 sc1
    buffer_load_dwordx4 v[236:239], v241, s[40:43], s83 offen offset:1024 sc1
    s_waitcnt lgkmcnt(8)
    v_mfma_f32_16x16x32_bf16 v[32:35], v[96:99], v[192:195], v[32:35]
    ds_read_b64_tr_b16 v[72:73], v253 offset:0
    v_add_u32 v246, s90, v242
    v_mfma_f32_16x16x32_bf16 v[32:35], v[100:103], v[200:203], v[32:35]
    ds_read_b64_tr_b16 v[74:75], v253 offset:512
    v_add_u32 v247, s90, v243
    v_mfma_f32_16x16x32_bf16 v[36:39], v[96:99], v[196:199], v[36:39]
    ds_read_b64_tr_b16 v[76:77], v253 offset:4096
    v_add_u32 v248, s90, v244
    v_mfma_f32_16x16x32_bf16 v[36:39], v[100:103], v[204:207], v[36:39]
    ds_read_b64_tr_b16 v[78:79], v253 offset:4608
    v_add_u32 v249, s90, v245
    s_waitcnt lgkmcnt(8)
    v_mfma_f32_16x16x32_bf16 v[40:43], v[104:107], v[192:195], v[40:43]
    ds_read_b64_tr_b16 v[80:81], v246 offset:0
    v_mfma_f32_16x16x32_bf16 v[40:43], v[108:111], v[200:203], v[40:43]
    ds_read_b64_tr_b16 v[82:83], v246 offset:512
    v_mfma_f32_16x16x32_bf16 v[44:47], v[104:107], v[196:199], v[44:47]
    ds_read_b64_tr_b16 v[84:85], v246 offset:4096
    v_mfma_f32_16x16x32_bf16 v[44:47], v[108:111], v[204:207], v[44:47]
    ds_read_b64_tr_b16 v[86:87], v246 offset:4608
    s_waitcnt lgkmcnt(8)
    v_mfma_f32_16x16x32_bf16 v[48:51], v[64:67], v[192:195], v[48:51]
    ds_read_b64_tr_b16 v[88:89], v247 offset:0
    s_waitcnt vmcnt(4)
    v_add3_u32 v26, v208, v209, v210
    v_add3_u32 v27, v211, v212, v213
    v_add3_u32 v26, v26, v214, v215
    v_mfma_f32_16x16x32_bf16 v[48:51], v[68:71], v[200:203], v[48:51]
    ds_read_b64_tr_b16 v[90:91], v247 offset:512
    v_add3_u32 v27, v27, v216, v217
    v_add3_u32 v26, v26, v218, v219
    v_add3_u32 v27, v27, v220, v221
    v_mfma_f32_16x16x32_bf16 v[52:55], v[64:67], v[196:199], v[52:55]
    ds_read_b64_tr_b16 v[92:93], v247 offset:4096
    v_add3_u32 v26, v26, v222, v223
    v_add_u32 v26, v26, v27
    v_mfma_f32_16x16x32_bf16 v[52:55], v[68:71], v[204:207], v[52:55]
    ds_read_b64_tr_b16 v[94:95], v247 offset:4608
    v_add_u32_dpp v26, v26, v26 row_ror:8 row_mask:0xf bank_mask:0xf
    s_waitcnt lgkmcnt(8)
    v_mfma_f32_16x16x32_bf16 v[56:59], v[72:75], v[192:195], v[56:59]
    ds_read_b64_tr_b16 v[96:97], v248 offset:0
    v_add_u32_dpp v26, v26, v26 row_ror:4 row_mask:0xf bank_mask:0xf
    v_mfma_f32_16x16x32_bf16 v[56:59], v[76:79], v[200:203], v[56:59]
    ds_read_b64_tr_b16 v[98:99], v248 offset:512
    v_add_u32_dpp v26, v26, v26 row_ror:2 row_mask:0xf bank_mask:0xf
    v_add_u32 v26, v26, v112
    v_mfma_f32_16x16x32_bf16 v[60:63], v[72:75], v[196:199], v[60:63]
    ds_read_b64_tr_b16 v[100:101], v248 offset:4096
    v_add_u32_dpp v26, v26, v26 quad_perm:[1,0,3,2] row_mask:0xf bank_mask:0xf
    v_cmp_ne_u32 vcc, s76, v26
    v_mfma_f32_16x16x32_bf16 v[60:63], v[76:79], v[204:207], v[60:63]
    ds_read_b64_tr_b16 v[102:103], v248 offset:4608
    s_and_b64 vcc, vcc, s[66:67]
    s_cbranch_vccnz L_rt2
L_ok2:
    s_lshl_b64 s[66:67], s[66:67], 2
    buffer_load_dwordx4 v[176:179], v240, s[40:43], s84 offen offset:0 sc1
    buffer_load_dwordx4 v[180:183], v241, s[40:43], s84 offen offset:0 sc1
    buffer_load_dwordx4 v[184:187], v240, s[40:43], s84 offen offset:1024 sc1
    buffer_load_dwordx4 v[188:191], v241, s[40:43], s84 offen offset:1024 sc1
    s_waitcnt lgkmcnt(8)
    v_mfma_f32_16x16x32_bf16 v[32:35], v[80:83], v[208:211], v[32:35]
    ds_read_b64_tr_b16 v[104:105], v249 offset:0
    v_add_u32 v250, s91, v242
    v_mfma_f32_16x16x32_bf16 v[32:35], v[84:87], v[216:219], v[32:35]
    ds_read_b64_tr_b16 v[106:107], v249 offset:512
    v_add_u32 v251, s91, v243
    v_mfma_f32_16x16x32_bf16 v[36:39], v[80:83], v[212:215], v[36:39]
    ds_read_b64_tr_b16 v[108:109], v249 offset:4096
    v_add_u32 v252, s91, v244
    v_mfma_f32_16x16x32_bf16 v[36:39], v[84:87], v[220:223], v[36:39]
    ds_read_b64_tr_b16 v[110:111], v249 offset:4608
    v_add_u32 v253, s91, v245
    s_waitcnt lgkmcnt(8)
    v_mfma_f32_16x16x32_bf16 v[40:43], v[88:91], v[208:211], v[40:43]
    ds_read_b64_tr_b16 v[64:65], v250 offset:0
    v_mfma_f32_16x16x32_bf16 v[40:43], v[92:95], v[216:219], v[40:43]
    ds_read_b64_tr_b16 v[66:67], v250 offset:512
    v_mfma_f32_16x16x32_bf16 v[44:47], v[88:91], v[212:215], v[44:47]
    ds_read_b64_tr_b16 v[68:69], v250 offset:4096
    v_mfma_f32_16x16x32_bf16 v[44:47], v[92:95], v[220:223], v[44:47]
    ds_read_b64_tr_b16 v[70:71], v250 offset:4608
    s_waitcnt lgkmcnt(8)
    v_mfma_f32_16x16x32_bf16 v[48:51], v[96:99], v[208:211], v[48:51]
    ds_read_b64_tr_b16 v[72:73], v251 offset:0
    s_waitcnt vmcnt(4)
    v_add3_u32 v26, v224, v225, v226
    v_add3_u32 v27, v227, v228, v229
    v_add3_u32 v26, v26, v230, v231
    v_mfma_f32_16x16x32_bf16 v[48:51], v[100:103], v[216:219], v[48:51]
    ds_read_b64_tr_b16 v[74:75], v251 offset:512
    v_add3_u32 v27, v27, v232, v233
    v_add3_u32 v26, v26, v234, v235
    v_add3_u32 v27, v27, v236, v237
    v_mfma_f32_16x16x32_bf16 v[52:55], v[96:99], v[212:215], v[52:55]
    ds_read_b64_tr_b16 v[76:77], v251 offset:4096
    v_add3_u32 v26, v26, v238, v239
    v_add_u32 v26, v26, v27
    v_mfma_f32_16x16x32_bf16 v[52:55], v[100:103], v[220:223], v[52:55]
    ds_read_b64_tr_b16 v[78:79], v251 offset:4608
    v_add_u32_dpp v26, v26, v26 row_ror:8 row_mask:0xf bank_mask:0xf
    s_waitcnt lgkmcnt(8)
    v_mfma_f32_16x16x32_bf16 v[56:59], v[104:107], v[208:211], v[56:59]
    ds_read_b64_tr_b16 v[80:81], v252 offset:0
    v_add_u32_dpp v26, v26, v26 row_ror:4 row_mask:0xf bank_mask:0xf
    v_mfma_f32_16x16x32_bf16 v[56:59], v[108:111], v[216:219], v[56:59]
    ds_read_b64_tr_b16 v[82:83], v252 offset:512
    v_add_u32_dpp v26, v26, v26 row_ror:2 row_mask:0xf bank_mask:0xf
    v_add_u32 v26, v26, v112
    v_mfma_f32_16x16x32_bf16 v[60:63], v[104:107], v[212:215], v[60:63]
    ds_read_b64_tr_b16 v[84:85], v252 offset:4096
    v_add_u32_dpp v26, v26, v26 quad_perm:[1,0,3,2] row_mask:0xf bank_mask:0xf
    v_cmp_ne_u32 vcc, s76, v26
    v_mfma_f32_16x16x32_bf16 v[60:63], v[108:111], v[220:223], v[60:63]
    ds_read_b64_tr_b16 v[86:87], v252 offset:4608
    s_and_b64 vcc, vcc, s[66:67]
    s_cbranch_vccnz L_rt3
L_ok3:
    s_lshl_b64 s[66:67], s[66:67], 2
    buffer_load_dwordx4 v[192:195], v240, s[40:43], s85 offen offset:0 sc1
    buffer_load_dwordx4 v[196:199], v241, s[40:43], s85 offen offset:0 sc1
    buffer_load_dwordx4 v[200:203], v240, s[40:43], s85 offen offset:1024 sc1
    buffer_load_dwordx4 v[204:207], v241, s[40:43], s85 offen offset:1024 sc1
    s_waitcnt lgkmcnt(8)
    v_mfma_f32_16x16x32_bf16 v[32:35], v[64:67], v[224:227], v[32:35]
    ds_read_b64_tr_b16 v[88:89], v253 offset:0
    v_add_u32 v246, s94, v242
    v_mfma_f32_16x16x32_bf16 v[32:35], v[68:71], v[232:235], v[32:35]
    ds_read_b64_tr_b16 v[90:91], v253 offset:512
    v_add_u32 v247, s94, v243
    v_mfma_f32_16x16x32_bf16 v[36:39], v[64:67], v[228:231], v[36:39]
    ds_read_b64_tr_b16 v[92:93], v253 offset:4096
    v_add_u32 v248, s94, v244
    v_mfma_f32_16x16x32_bf16 v[36:39], v[68:71], v[236:239], v[36:39]
    ds_read_b64_tr_b16 v[94:95], v253 offset:4608
    v_add_u32 v249, s94, v245
    s_waitcnt lgkmcnt(8)
    v_mfma_f32_16x16x32_bf16 v[40:43], v[72:75], v[224:227], v[40:43]
    ds_read_b64_tr_b16 v[96:97], v246 offset:0
    v_mfma_f32_16x16x32_bf16 v[40:43], v[76:79], v[232:235], v[40:43]
    ds_read_b64_tr_b16 v[98:99], v246 offset:512
    v_mfma_f32_16x16x32_bf16 v[44:47], v[72:75], v[228:231], v[44:47]
    ds_read_b64_tr_b16 v[100:101], v246 offset:4096
    v_mfma_f32_16x16x32_bf16 v[44:47], v[76:79], v[236:239], v[44:47]
    ds_read_b64_tr_b16 v[102:103], v246 offset:4608
    s_waitcnt lgkmcnt(8)
    v_mfma_f32_16x16x32_bf16 v[48:51], v[80:83], v[224:227], v[48:51]
    ds_read_b64_tr_b16 v[104:105], v247 offset:0
    s_waitcnt vmcnt(4)
    v_add3_u32 v26, v176, v177, v178
    v_add3_u32 v27, v179, v180, v181
    v_add3_u32 v26, v26, v182, v183
    v_mfma_f32_16x16x32_bf16 v[48:51], v[84:87], v[232:235], v[48:51]
    ds_read_b64_tr_b16 v[106:107], v247 offset:512
    v_add3_u32 v27, v27, v184, v185
    v_add3_u32 v26, v26, v186, v187
    v_add3_u32 v27, v27, v188, v189
    v_mfma_f32_16x16x32_bf16 v[52:55], v[80:83], v[228:231], v[52:55]
    ds_read_b64_tr_b16 v[108:109], v247 offset:4096
    v_add3_u32 v26, v26, v190, v191
    v_add_u32 v26, v26, v27
    v_mfma_f32_16x16x32_bf16 v[52:55], v[84:87], v[236:239], v[52:55]
    ds_read_b64_tr_b16 v[110:111], v247 offset:4608
    v_add_u32_dpp v26, v26, v26 row_ror:8 row_mask:0xf bank_mask:0xf
    s_waitcnt lgkmcnt(8)
    v_mfma_f32_16x16x32_bf16 v[56:59], v[88:91], v[224:227], v[56:59]
    ds_read_b64_tr_b16 v[64:65], v248 offset:0
    v_add_u32_dpp v26, v26, v26 row_ror:4 row_mask:0xf bank_mask:0xf
    v_mfma_f32_16x16x32_bf16 v[56:59], v[92:95], v[232:235], v[56:59]
    ds_read_b64_tr_b16 v[66:67], v248 offset:512
    v_add_u32_dpp v26, v26, v26 row_ror:2 row_mask:0xf bank_mask:0xf
    v_add_u32 v26, v26, v112
    v_mfma_f32_16x16x32_bf16 v[60:63], v[88:91], v[228:231], v[60:63]
    ds_read_b64_tr_b16 v[68:69], v248 offset:4096
    v_add_u32_dpp v26, v26, v26 quad_perm:[1,0,3,2] row_mask:0xf bank_mask:0xf
    v_cmp_ne_u32 vcc, s76, v26
    v_mfma_f32_16x16x32_bf16 v[60:63], v[92:95], v[236:239], v[60:63]
    ds_read_b64_tr_b16 v[70:71], v248 offset:4608
    s_and_b64 vcc, vcc, s[66:67]
    s_cbranch_vccnz L_rt4
L_ok4:
    s_lshl_b64 s[66:67], s[66:67], 2
    buffer_load_dwordx4 v[208:211], v240, s[40:43], s86 offen offset:0 sc1
    buffer_load_dwordx4 v[212:215], v241, s[40:43], s86 offen offset:0 sc1
    buffer_load_dwordx4 v[216:219], v240, s[40:43], s86 offen offset:1024 sc1
    buffer_load_dwordx4 v[220:223], v241, s[40:43], s86 offen offset:1024 sc1
    s_waitcnt lgkmcnt(8)
    v_mfma_f32_16x16x32_bf16 v[32:35], v[96:99], v[176:179], v[32:35]
    ds_read_b64_tr_b16 v[72:73], v249 offset:0
    v_add_u32 v250, s95, v242
    v_mfma_f32_16x16x32_bf16 v[32:35], v[100:103], v[184:187], v[32:35]
    ds_read_b64_tr_b16 v[74:75], v249 offset:512
    v_add_u32 v251, s95, v243
    v_mfma_f32_16x16x32_bf16 v[36:39], v[96:99], v[180:183], v[36:39]
    ds_read_b64_tr_b16 v[76:77], v249 offset:4096
    v_add_u32 v252, s95, v244
    v_mfma_f32_16x16x32_bf16 v[36:39], v[100:103], v[188:191], v[36:39]
    ds_read_b64_tr_b16 v[78:79], v249 offset:4608
    v_add_u32 v253, s95, v245
    s_waitcnt lgkmcnt(8)
    v_mfma_f32_16x16x32_bf16 v[40:43], v[104:107], v[176:179], v[40:43]
    ds_read_b64_tr_b16 v[80:81], v250 offset:0
    v_mfma_f32_16x16x32_bf16 v[40:43], v[108:111], v[184:187], v[40:43]
    ds_read_b64_tr_b16 v[82:83], v250 offset:512
    v_mfma_f32_16x16x32_bf16 v[44:47], v[104:107], v[180:183], v[44:47]
    ds_read_b64_tr_b16 v[84:85], v250 offset:4096
    v_mfma_f32_16x16x32_bf16 v[44:47], v[108:111], v[188:191], v[44:47]
    ds_read_b64_tr_b16 v[86:87], v250 offset:4608
    s_waitcnt lgkmcnt(8)
    v_mfma_f32_16x16x32_bf16 v[48:51], v[64:67], v[176:179], v[48:51]
    ds_read_b64_tr_b16 v[88:89], v251 offset:0
    s_waitcnt vmcnt(4)
    v_add3_u32 v26, v192, v193, v194
    v_add3_u32 v27, v195, v196, v197
    v_add3_u32 v26, v26, v198, v199
    v_mfma_f32_16x16x32_bf16 v[48:51], v[68:71], v[184:187], v[48:51]
    ds_read_b64_tr_b16 v[90:91], v251 offset:512
    v_add3_u32 v27, v27, v200, v201
    v_add3_u32 v26, v26, v202, v203
    v_add3_u32 v27, v27, v204, v205
    v_mfma_f32_16x16x32_bf16 v[52:55], v[64:67], v[180:183], v[52:55]
    ds_read_b64_tr_b16 v[92:93], v251 offset:4096
    v_add3_u32 v26, v26, v206, v207
    v_add_u32 v26, v26, v27
    v_mfma_f32_16x16x32_bf16 v[52:55], v[68:71], v[188:191], v[52:55]
    ds_read_b64_tr_b16 v[94:95], v251 offset:4608
    v_add_u32_dpp v26, v26, v26 row_ror:8 row_mask:0xf bank_mask:0xf
    s_waitcnt lgkmcnt(8)
    v_mfma_f32_16x16x32_bf16 v[56:59], v[72:75], v[176:179], v[56:59]
    ds_read_b64_tr_b16 v[96:97], v252 offset:0
    v_add_u32_dpp v26, v26, v26 row_ror:4 row_mask:0xf bank_mask:0xf
    v_mfma_f32_16x16x32_bf16 v[56:59], v[76:79], v[184:187], v[56:59]
    ds_read_b64_tr_b16 v[98:99], v252 offset:512
    v_add_u32_dpp v26, v26, v26 row_ror:2 row_mask:0xf bank_mask:0xf
    v_add_u32 v26, v26, v112
    v_mfma_f32_16x16x32_bf16 v[60:63], v[72:75], v[180:183], v[60:63]
    ds_read_b64_tr_b16 v[100:101], v252 offset:4096
    v_add_u32_dpp v26, v26, v26 quad_perm:[1,0,3,2] row_mask:0xf bank_mask:0xf
    v_cmp_ne_u32 vcc, s76, v26
    v_mfma_f32_16x16x32_bf16 v[60:63], v[76:79], v[188:191], v[60:63]
    ds_read_b64_tr_b16 v[102:103], v252 offset:4608
    s_and_b64 vcc, vcc, s[66:67]
    s_cbranch_vccnz L_rt5
L_ok5:
    s_lshl_b64 s[66:67], s[66:67], 2
    buffer_load_dwordx4 v[224:227], v240, s[40:43], s87 offen offset:0 sc1
    buffer_load_dwordx4 v[228:231], v241, s[40:43], s87 offen offset:0 sc1
    buffer_load_dwordx4 v[232:235], v240, s[40:43], s87 offen offset:1024 sc1
    buffer_load_dwordx4 v[236:239], v241, s[40:43], s87 offen offset:1024 sc1
    s_waitcnt lgkmcnt(8)
    v_mfma_f32_16x16x32_bf16 v[32:35], v[80:83], v[192:195], v[32:35]
    ds_read_b64_tr_b16 v[104:105], v253 offset:0
    v_add_u32 v246, s96, v242
    v_mfma_f32_16x16x32_bf16 v[32:35], v[84:87], v[200:203], v[32:35]
    ds_read_b64_tr_b16 v[106:107], v253 offset:512
    v_add_u32 v247, s96, v243
    v_mfma_f32_16x16x32_bf16 v[36:39], v[80:83], v[196:199], v[36:39]
    ds_read_b64_tr_b16 v[108:109], v253 offset:4096
    v_add_u32 v248, s96, v244
    v_mfma_f32_16x16x32_bf16 v[36:39], v[84:87], v[204:207], v[36:39]
    ds_read_b64_tr_b16 v[110:111], v253 offset:4608
    v_add_u32 v249, s96, v245
    s_waitcnt lgkmcnt(8)
    v_mfma_f32_16x16x32_bf16 v[40:43], v[88:91], v[192:195], v[40:43]
    ds_read_b64_tr_b16 v[64:65], v246 offset:0
    v_mfma_f32_16x16x32_bf16 v[40:43], v[92:95], v[200:203], v[40:43]
    ds_read_b64_tr_b16 v[66:67], v246 offset:512
    v_mfma_f32_16x16x32_bf16 v[44:47], v[88:91], v[196:199], v[44:47]
    ds_read_b64_tr_b16 v[68:69], v246 offset:4096
    v_mfma_f32_16x16x32_bf16 v[44:47], v[92:95], v[204:207], v[44:47]
    ds_read_b64_tr_b16 v[70:71], v246 offset:4608
    s_waitcnt lgkmcnt(8)
    v_mfma_f32_16x16x32_bf16 v[48:51], v[96:99], v[192:195], v[48:51]
    ds_read_b64_tr_b16 v[72:73], v247 offset:0
    s_waitcnt vmcnt(4)
    v_add3_u32 v26, v208, v209, v210
    v_add3_u32 v27, v211, v212, v213
    v_add3_u32 v26, v26, v214, v215
    v_mfma_f32_16x16x32_bf16 v[48:51], v[100:103], v[200:203], v[48:51]
    ds_read_b64_tr_b16 v[74:75], v247 offset:512
    v_add3_u32 v27, v27, v216, v217
    v_add3_u32 v26, v26, v218, v219
    v_add3_u32 v27, v27, v220, v221
    v_mfma_f32_16x16x32_bf16 v[52:55], v[96:99], v[196:199], v[52:55]
    ds_read_b64_tr_b16 v[76:77], v247 offset:4096
    v_add3_u32 v26, v26, v222, v223
    v_add_u32 v26, v26, v27
    v_mfma_f32_16x16x32_bf16 v[52:55], v[100:103], v[204:207], v[52:55]
    ds_read_b64_tr_b16 v[78:79], v247 offset:4608
    v_add_u32_dpp v26, v26, v26 row_ror:8 row_mask:0xf bank_mask:0xf
    s_waitcnt lgkmcnt(8)
    v_mfma_f32_16x16x32_bf16 v[56:59], v[104:107], v[192:195], v[56:59]
    ds_read_b64_tr_b16 v[80:81], v248 offset:0
    v_add_u32_dpp v26, v26, v26 row_ror:4 row_mask:0xf bank_mask:0xf
    v_mfma_f32_16x16x32_bf16 v[56:59], v[108:111], v[200:203], v[56:59]
    ds_read_b64_tr_b16 v[82:83], v248 offset:512
    v_add_u32_dpp v26, v26, v26 row_ror:2 row_mask:0xf bank_mask:0xf
    v_add_u32 v26, v26, v112
    v_mfma_f32_16x16x32_bf16 v[60:63], v[104:107], v[196:199], v[60:63]
    ds_read_b64_tr_b16 v[84:85], v248 offset:4096
    v_add_u32_dpp v26, v26, v26 quad_perm:[1,0,3,2] row_mask:0xf bank_mask:0xf
    v_cmp_ne_u32 vcc, s76, v26
    v_mfma_f32_16x16x32_bf16 v[60:63], v[108:111], v[204:207], v[60:63]
    ds_read_b64_tr_b16 v[86:87], v248 offset:4608
    s_and_b64 vcc, vcc, s[66:67]
    s_cbranch_vccnz L_rt6
L_ok6:
    s_lshl_b64 s[66:67], s[66:67], 2
    s_waitcnt lgkmcnt(8)
    v_mfma_f32_16x16x32_bf16 v[32:35], v[64:67], v[208:211], v[32:35]
    ds_read_b64_tr_b16 v[88:89], v249 offset:0
    v_add_u32 v250, s97, v242
    v_mfma_f32_16x16x32_bf16 v[32:35], v[68:71], v[216:219], v[32:35]
    ds_read_b64_tr_b16 v[90:91], v249 offset:512
    v_add_u32 v251, s97, v243
    v_mfma_f32_16x16x32_bf16 v[36:39], v[64:67], v[212:215], v[36:39]
    ds_read_b64_tr_b16 v[92:93], v249 offset:4096
    v_add_u32 v252, s97, v244
    v_mfma_f32_16x16x32_bf16 v[36:39], v[68:71], v[220:223], v[36:39]
    ds_read_b64_tr_b16 v[94:95], v249 offset:4608
    v_add_u32 v253, s97, v245
    s_waitcnt lgkmcnt(8)
    v_mfma_f32_16x16x32_bf16 v[40:43], v[72:75], v[208:211], v[40:43]
    ds_read_b64_tr_b16 v[96:97], v250 offset:0
    v_mfma_f32_16x16x32_bf16 v[40:43], v[76:79], v[216:219], v[40:43]
    ds_read_b64_tr_b16 v[98:99], v250 offset:512
    v_mfma_f32_16x16x32_bf16 v[44:47], v[72:75], v[212:215], v[44:47]
    ds_read_b64_tr_b16 v[100:101], v250 offset:4096
    v_mfma_f32_16x16x32_bf16 v[44:47], v[76:79], v[220:223], v[44:47]
    ds_read_b64_tr_b16 v[102:103], v250 offset:4608
    s_waitcnt lgkmcnt(8)
    v_mfma_f32_16x16x32_bf16 v[48:51], v[80:83], v[208:211], v[48:51]
    ds_read_b64_tr_b16 v[104:105], v251 offset:0
    s_waitcnt vmcnt(0)
    v_add3_u32 v26, v224, v225, v226
    v_add3_u32 v27, v227, v228, v229
    v_add3_u32 v26, v26, v230, v231
    v_mfma_f32_16x16x32_bf16 v[48:51], v[84:87], v[216:219], v[48:51]
    ds_read_b64_tr_b16 v[106:107], v251 offset:512
    v_add3_u32 v27, v27, v232, v233
    v_add3_u32 v26, v26, v234, v235
    v_add3_u32 v27, v27, v236, v237
    v_mfma_f32_16x16x32_bf16 v[52:55], v[80:83], v[212:215], v[52:55]
    ds_read_b64_tr_b16 v[108:109], v251 offset:4096
    v_add3_u32 v26, v26, v238, v239
    v_add_u32 v26, v26, v27
    v_mfma_f32_16x16x32_bf16 v[52:55], v[84:87], v[220:223], v[52:55]
    ds_read_b64_tr_b16 v[110:111], v251 offset:4608
    v_add_u32_dpp v26, v26, v26 row_ror:8 row_mask:0xf bank_mask:0xf
    s_waitcnt lgkmcnt(8)
    v_mfma_f32_16x16x32_bf16 v[56:59], v[88:91], v[208:211], v[56:59]
    ds_read_b64_tr_b16 v[64:65], v252 offset:0
    v_add_u32_dpp v26, v26, v26 row_ror:4 row_mask:0xf bank_mask:0xf
    v_mfma_f32_16x16x32_bf16 v[56:59], v[92:95], v[216:219], v[56:59]
    ds_read_b64_tr_b16 v[66:67], v252 offset:512
    v_add_u32_dpp v26, v26, v26 row_ror:2 row_mask:0xf bank_mask:0xf
    v_add_u32 v26, v26, v112
    v_mfma_f32_16x16x32_bf16 v[60:63], v[88:91], v[212:215], v[60:63]
    ds_read_b64_tr_b16 v[68:69], v252 offset:4096
    v_add_u32_dpp v26, v26, v26 quad_perm:[1,0,3,2] row_mask:0xf bank_mask:0xf
    v_cmp_ne_u32 vcc, s76, v26
    v_mfma_f32_16x16x32_bf16 v[60:63], v[92:95], v[220:223], v[60:63]
    ds_read_b64_tr_b16 v[70:71], v252 offset:4608
    s_and_b64 vcc, vcc, s[66:67]
    s_cbranch_vccnz L_rt7
L_ok7:
    s_waitcnt lgkmcnt(8)
    v_mfma_f32_16x16x32_bf16 v[36:39], v[96:99], v[228:231], v[36:39]
    ds_read_b64_tr_b16 v[72:73], v253 offset:0
    ds_read_b64_tr_b16 v[74:75], v253 offset:512
    v_mfma_f32_16x16x32_bf16 v[36:39], v[100:103], v[236:239], v[36:39]
    ds_read_b64_tr_b16 v[76:77], v253 offset:4096
    ds_read_b64_tr_b16 v[78:79], v253 offset:4608
    s_waitcnt lgkmcnt(8)
    v_mfma_f32_16x16x32_bf16 v[44:47], v[104:107], v[228:231], v[44:47]
    v_mfma_f32_16x16x32_bf16 v[44:47], v[108:111], v[236:239], v[44:47]
    s_waitcnt lgkmcnt(4)
    v_mfma_f32_16x16x32_bf16 v[52:55], v[64:67], v[228:231], v[52:55]
    v_mfma_f32_16x16x32_bf16 v[52:55], v[68:71], v[236:239], v[52:55]
    v_mfma_f32_16x16x32_bf16 v[32:35], v[96:99], v[224:227], v[32:35]
    v_mfma_f32_16x16x32_bf16 v[32:35], v[100:103], v[232:235], v[32:35]
    s_waitcnt lgkmcnt(0)
    v_mfma_f32_16x16x32_bf16 v[60:63], v[72:75], v[228:231], v[60:63]
    v_mfma_f32_16x16x32_bf16 v[60:63], v[76:79], v[236:239], v[60:63]
    v_mfma_f32_16x16x32_bf16 v[40:43], v[104:107], v[224:227], v[40:43]
    ds_write_b128 v138, v[36:39] offset:0
    v_mfma_f32_16x16x32_bf16 v[40:43], v[108:111], v[232:235], v[40:43]
    ds_write_b128 v138, v[44:47] offset:1024
    v_mfma_f32_16x16x32_bf16 v[48:51], v[64:67], v[224:227], v[48:51]
    ds_write_b128 v138, v[52:55] offset:2048
    v_mfma_f32_16x16x32_bf16 v[48:51], v[68:71], v[232:235], v[48:51]
    s_nop 0
    ds_write_b128 v138, v[60:63] offset:3072
    v_mfma_f32_16x16x32_bf16 v[56:59], v[72:75], v[224:227], v[56:59]
    v_mfma_f32_16x16x32_bf16 v[56:59], v[76:79], v[232:235], v[56:59]
    s_waitcnt lgkmcnt(0)
    s_barrier
    ds_read_b128 v[176:179], v139 offset:0
    ds_read_b128 v[180:183], v139 offset:1024
    ds_read_b128 v[184:187], v139 offset:2048
    ds_read_b128 v[188:191], v139 offset:3072
    s_waitcnt lgkmcnt(2)
    v_pk_add_f32 v[176:177], v[176:177], v[32:33]
    v_pk_add_f32 v[178:179], v[178:179], v[34:35]
    v_pk_add_f32 v[180:181], v[180:181], v[40:41]
    v_pk_add_f32 v[182:183], v[182:183], v[42:43]
    v_cvt_pk_bf16_f32 v96, v176, v177
    v_cvt_pk_bf16_f32 v97, v178, v179
    v_cvt_pk_bf16_f32 v98, v180, v181
    v_cvt_pk_bf16_f32 v99, v182, v183
    s_nop 0
    v_permlane16_swap_b32 v96, v98
    v_permlane16_swap_b32 v97, v99
    buffer_store_dwordx4 v[96:99], v140, s[36:39], s79 offen offset:0
    s_waitcnt lgkmcnt(0)
    v_pk_add_f32 v[184:185], v[184:185], v[48:49]
    v_pk_add_f32 v[186:187], v[186:187], v[50:51]
    v_pk_add_f32 v[188:189], v[188:189], v[56:57]
    v_pk_add_f32 v[190:191], v[190:191], v[58:59]
    v_cvt_pk_bf16_f32 v100, v184, v185
    v_cvt_pk_bf16_f32 v101, v186, v187
    v_cvt_pk_bf16_f32 v102, v188, v189
    v_cvt_pk_bf16_f32 v103, v190, v191
    s_nop 0
    v_permlane16_swap_b32 v100, v102
    v_permlane16_swap_b32 v101, v103
    buffer_store_dwordx4 v[100:103], v140, s[36:39], s79 offen offset:64
L_fin:
L_end:
    s_endpgm
L_tag:
    s_mov_b32 s59, 0x10000
L_tag_l:
    buffer_load_dword v36, off, s[44:47], 0 sc1
    s_waitcnt vmcnt(0)
    v_readfirstlane_b32 s92, v36
    s_cmp_lg_u32 s92, 0
    s_cbranch_scc1 L_tag_ok
    s_sub_u32 s59, s59, 1
    s_cbranch_scc0 L_tag_l
    s_branch L_tag_ok
L_slow:
    s_mov_b32 s59, 0x10000
L_flg:
    v_cmp_le_u32 vcc, 8, v36
    s_cbranch_vccz L_flg_ok
    buffer_load_dwordx4 v[36:39], v132, s[40:43], 0 offen sc1
    s_waitcnt vmcnt(0)
    v_xor_b32 v36, s70, v36
    v_xor_b32 v37, s70, v37
    v_xor_b32 v38, s70, v38
    v_xor_b32 v39, s70, v39
    v_or3_b32 v36, v36, v37, v38
    v_or_b32 v36, v36, v39
    s_sub_u32 s59, s59, 1
    s_cbranch_scc0 L_flg
L_flg_ok:
    v_cmp_ne_u32 vcc, 0, v36
    s_cbranch_vccz L_loc
    s_mov_b32 s93, 0
    s_branch L_sp_x
L_sp_x:
    s_nop 7
    v_perm_b32 v40, v40, v135, s8
    v_perm_b32 v41, v41, v135, s9
    v_perm_b32 v42, v42, v135, s10
    v_perm_b32 v43, v43, v135, s11
    buffer_store_dwordx4 v[40:43], v10, s[36:39], s66 offen sc1
    v_perm_b32 v44, v44, v135, s8
    v_perm_b32 v45, v45, v135, s9
    v_perm_b32 v46, v46, v135, s10
    v_perm_b32 v47, v47, v135, s11
    buffer_store_dwordx4 v[44:47], v10, s[36:39], s67 offen sc1
    v_perm_b32 v48, v48, v135, s8
    v_perm_b32 v49, v49, v135, s9
    v_perm_b32 v50, v50, v135, s10
    v_perm_b32 v51, v51, v135, s11
    buffer_store_dwordx4 v[48:51], v10, s[36:39], s53 offen sc1
    v_perm_b32 v52, v52, v135, s8
    v_perm_b32 v53, v53, v135, s9
    v_perm_b32 v54, v54, v135, s10
    v_perm_b32 v55, v55, v135, s11
    buffer_store_dwordx4 v[52:55], v10, s[36:39], s54 offen sc1
    v_cndmask_b32 v56, v56, v60, s[64:65]
    s_mov_b32 exec_hi, 0
    buffer_store_dword v56, v136, s[40:43], s68 offen sc1
    s_mov_b32 exec_hi, -1
    s_branch L_sp_j
L_sf_x:
    s_nop 7
    buffer_store_dword v64, v24, s[40:43], s69 offen sc1
    s_branch L_sf_j
L_mktag:
    s_waitcnt lgkmcnt(0)
    s_memrealtime s[54:55]
    s_mov_b32 s44, s14
    s_and_b32 s45, s15, 0xffff
    s_mov_b32 s46, 0x100
    s_mov_b32 s47, 0x20000
    s_waitcnt lgkmcnt(0)
    s_lshl_b32 s54, s54, 3
    s_bitset1_b32 s54, 31
    v_mov_b32 v224, s54
    s_mov_b64 exec, 1
    buffer_store_dword v224, off, s[44:47], 0 sc1
    s_mov_b64 exec, -1
    s_branch L_notag
L_rt1:
    s_mov_b32 s59, 0x10000
L_rt1_l:
    buffer_load_dword v112, v141, s[40:43], 0 offen sc1
    buffer_load_dwordx4 v[192:195], v240, s[40:43], s81 offen offset:0 sc1
    buffer_load_dwordx4 v[196:199], v241, s[40:43], s81 offen offset:0 sc1
    buffer_load_dwordx4 v[200:203], v240, s[40:43], s81 offen offset:1024 sc1
    buffer_load_dwordx4 v[204:207], v241, s[40:43], s81 offen offset:1024 sc1
    s_waitcnt vmcnt(0)
    v_add3_u32 v26, v192, v193, v194
    v_add3_u32 v27, v195, v196, v197
    v_add3_u32 v26, v26, v198, v199
    v_add3_u32 v27, v27, v200, v201
    v_add3_u32 v26, v26, v202, v203
    v_add3_u32 v27, v27, v204, v205
    v_add3_u32 v26, v26, v206, v207
    v_add_u32 v26, v26, v27
    s_nop 1
    v_add_u32_dpp v26, v26, v26 row_ror:8 row_mask:0xf bank_mask:0xf
    s_nop 1
    v_add_u32_dpp v26, v26, v26 row_ror:4 row_mask:0xf bank_mask:0xf
    s_nop 1
    v_add_u32_dpp v26, v26, v26 row_ror:2 row_mask:0xf bank_mask:0xf
    v_add_u32 v26, v26, v112
    s_nop 1
    v_add_u32_dpp v26, v26, v26 quad_perm:[1,0,3,2] row_mask:0xf bank_mask:0xf
    v_cmp_ne_u32 vcc, s76, v26
    s_and_b64 vcc, vcc, s[66:67]
    s_cbranch_vccz L_ok1
    s_sub_u32 s59, s59, 1
    s_cbranch_scc0 L_rt1_l
    s_branch L_ok1
L_rt2:
    s_mov_b32 s59, 0x10000
L_rt2_l:
    buffer_load_dword v112, v141, s[40:43], 0 offen sc1
    buffer_load_dwordx4 v[208:211], v240, s[40:43], s82 offen offset:0 sc1
    buffer_load_dwordx4 v[212:215], v241, s[40:43], s82 offen offset:0 sc1
    buffer_load_dwordx4 v[216:219], v240, s[40:43], s82 offen offset:1024 sc1
    buffer_load_dwordx4 v[220:223], v241, s[40:43], s82 offen offset:1024 sc1
    s_waitcnt vmcnt(0)
    v_add3_u32 v26, v208, v209, v210
    v_add3_u32 v27, v211, v212, v213
    v_add3_u32 v26, v26, v214, v215
    v_add3_u32 v27, v27, v216, v217
    v_add3_u32 v26, v26, v218, v219
    v_add3_u32 v27, v27, v220, v221
    v_add3_u32 v26, v26, v222, v223
    v_add_u32 v26, v26, v27
    s_nop 1
    v_add_u32_dpp v26, v26, v26 row_ror:8 row_mask:0xf bank_mask:0xf
    s_nop 1
    v_add_u32_dpp v26, v26, v26 row_ror:4 row_mask:0xf bank_mask:0xf
    s_nop 1
    v_add_u32_dpp v26, v26, v26 row_ror:2 row_mask:0xf bank_mask:0xf
    v_add_u32 v26, v26, v112
    s_nop 1
    v_add_u32_dpp v26, v26, v26 quad_perm:[1,0,3,2] row_mask:0xf bank_mask:0xf
    v_cmp_ne_u32 vcc, s76, v26
    s_and_b64 vcc, vcc, s[66:67]
    s_cbranch_vccz L_ok2
    s_sub_u32 s59, s59, 1
    s_cbranch_scc0 L_rt2_l
    s_branch L_ok2
L_rt3:
    s_mov_b32 s59, 0x10000
L_rt3_l:
    buffer_load_dword v112, v141, s[40:43], 0 offen sc1
    buffer_load_dwordx4 v[224:227], v240, s[40:43], s83 offen offset:0 sc1
    buffer_load_dwordx4 v[228:231], v241, s[40:43], s83 offen offset:0 sc1
    buffer_load_dwordx4 v[232:235], v240, s[40:43], s83 offen offset:1024 sc1
    buffer_load_dwordx4 v[236:239], v241, s[40:43], s83 offen offset:1024 sc1
    s_waitcnt vmcnt(0)
    v_add3_u32 v26, v224, v225, v226
    v_add3_u32 v27, v227, v228, v229
    v_add3_u32 v26, v26, v230, v231
    v_add3_u32 v27, v27, v232, v233
    v_add3_u32 v26, v26, v234, v235
    v_add3_u32 v27, v27, v236, v237
    v_add3_u32 v26, v26, v238, v239
    v_add_u32 v26, v26, v27
    s_nop 1
    v_add_u32_dpp v26, v26, v26 row_ror:8 row_mask:0xf bank_mask:0xf
    s_nop 1
    v_add_u32_dpp v26, v26, v26 row_ror:4 row_mask:0xf bank_mask:0xf
    s_nop 1
    v_add_u32_dpp v26, v26, v26 row_ror:2 row_mask:0xf bank_mask:0xf
    v_add_u32 v26, v26, v112
    s_nop 1
    v_add_u32_dpp v26, v26, v26 quad_perm:[1,0,3,2] row_mask:0xf bank_mask:0xf
    v_cmp_ne_u32 vcc, s76, v26
    s_and_b64 vcc, vcc, s[66:67]
    s_cbranch_vccz L_ok3
    s_sub_u32 s59, s59, 1
    s_cbranch_scc0 L_rt3_l
    s_branch L_ok3
L_rt4:
    s_mov_b32 s59, 0x10000
L_rt4_l:
    buffer_load_dword v112, v141, s[40:43], 0 offen sc1
    buffer_load_dwordx4 v[176:179], v240, s[40:43], s84 offen offset:0 sc1
    buffer_load_dwordx4 v[180:183], v241, s[40:43], s84 offen offset:0 sc1
    buffer_load_dwordx4 v[184:187], v240, s[40:43], s84 offen offset:1024 sc1
    buffer_load_dwordx4 v[188:191], v241, s[40:43], s84 offen offset:1024 sc1
    s_waitcnt vmcnt(0)
    v_add3_u32 v26, v176, v177, v178
    v_add3_u32 v27, v179, v180, v181
    v_add3_u32 v26, v26, v182, v183
    v_add3_u32 v27, v27, v184, v185
    v_add3_u32 v26, v26, v186, v187
    v_add3_u32 v27, v27, v188, v189
    v_add3_u32 v26, v26, v190, v191
    v_add_u32 v26, v26, v27
    s_nop 1
    v_add_u32_dpp v26, v26, v26 row_ror:8 row_mask:0xf bank_mask:0xf
    s_nop 1
    v_add_u32_dpp v26, v26, v26 row_ror:4 row_mask:0xf bank_mask:0xf
    s_nop 1
    v_add_u32_dpp v26, v26, v26 row_ror:2 row_mask:0xf bank_mask:0xf
    v_add_u32 v26, v26, v112
    s_nop 1
    v_add_u32_dpp v26, v26, v26 quad_perm:[1,0,3,2] row_mask:0xf bank_mask:0xf
    v_cmp_ne_u32 vcc, s76, v26
    s_and_b64 vcc, vcc, s[66:67]
    s_cbranch_vccz L_ok4
    s_sub_u32 s59, s59, 1
    s_cbranch_scc0 L_rt4_l
    s_branch L_ok4
L_rt5:
    s_mov_b32 s59, 0x10000
L_rt5_l:
    buffer_load_dword v112, v141, s[40:43], 0 offen sc1
    buffer_load_dwordx4 v[192:195], v240, s[40:43], s85 offen offset:0 sc1
    buffer_load_dwordx4 v[196:199], v241, s[40:43], s85 offen offset:0 sc1
    buffer_load_dwordx4 v[200:203], v240, s[40:43], s85 offen offset:1024 sc1
    buffer_load_dwordx4 v[204:207], v241, s[40:43], s85 offen offset:1024 sc1
    s_waitcnt vmcnt(0)
    v_add3_u32 v26, v192, v193, v194
    v_add3_u32 v27, v195, v196, v197
    v_add3_u32 v26, v26, v198, v199
    v_add3_u32 v27, v27, v200, v201
    v_add3_u32 v26, v26, v202, v203
    v_add3_u32 v27, v27, v204, v205
    v_add3_u32 v26, v26, v206, v207
    v_add_u32 v26, v26, v27
    s_nop 1
    v_add_u32_dpp v26, v26, v26 row_ror:8 row_mask:0xf bank_mask:0xf
    s_nop 1
    v_add_u32_dpp v26, v26, v26 row_ror:4 row_mask:0xf bank_mask:0xf
    s_nop 1
    v_add_u32_dpp v26, v26, v26 row_ror:2 row_mask:0xf bank_mask:0xf
    v_add_u32 v26, v26, v112
    s_nop 1
    v_add_u32_dpp v26, v26, v26 quad_perm:[1,0,3,2] row_mask:0xf bank_mask:0xf
    v_cmp_ne_u32 vcc, s76, v26
    s_and_b64 vcc, vcc, s[66:67]
    s_cbranch_vccz L_ok5
    s_sub_u32 s59, s59, 1
    s_cbranch_scc0 L_rt5_l
    s_branch L_ok5
L_rt6:
    s_mov_b32 s59, 0x10000
L_rt6_l:
    buffer_load_dword v112, v141, s[40:43], 0 offen sc1
    buffer_load_dwordx4 v[208:211], v240, s[40:43], s86 offen offset:0 sc1
    buffer_load_dwordx4 v[212:215], v241, s[40:43], s86 offen offset:0 sc1
    buffer_load_dwordx4 v[216:219], v240, s[40:43], s86 offen offset:1024 sc1
    buffer_load_dwordx4 v[220:223], v241, s[40:43], s86 offen offset:1024 sc1
    s_waitcnt vmcnt(0)
    v_add3_u32 v26, v208, v209, v210
    v_add3_u32 v27, v211, v212, v213
    v_add3_u32 v26, v26, v214, v215
    v_add3_u32 v27, v27, v216, v217
    v_add3_u32 v26, v26, v218, v219
    v_add3_u32 v27, v27, v220, v221
    v_add3_u32 v26, v26, v222, v223
    v_add_u32 v26, v26, v27
    s_nop 1
    v_add_u32_dpp v26, v26, v26 row_ror:8 row_mask:0xf bank_mask:0xf
    s_nop 1
    v_add_u32_dpp v26, v26, v26 row_ror:4 row_mask:0xf bank_mask:0xf
    s_nop 1
    v_add_u32_dpp v26, v26, v26 row_ror:2 row_mask:0xf bank_mask:0xf
    v_add_u32 v26, v26, v112
    s_nop 1
    v_add_u32_dpp v26, v26, v26 quad_perm:[1,0,3,2] row_mask:0xf bank_mask:0xf
    v_cmp_ne_u32 vcc, s76, v26
    s_and_b64 vcc, vcc, s[66:67]
    s_cbranch_vccz L_ok6
    s_sub_u32 s59, s59, 1
    s_cbranch_scc0 L_rt6_l
    s_branch L_ok6
L_rt7:
    s_mov_b32 s59, 0x10000
L_rt7_l:
    buffer_load_dword v112, v141, s[40:43], 0 offen sc1
    buffer_load_dwordx4 v[224:227], v240, s[40:43], s87 offen offset:0 sc1
    buffer_load_dwordx4 v[228:231], v241, s[40:43], s87 offen offset:0 sc1
    buffer_load_dwordx4 v[232:235], v240, s[40:43], s87 offen offset:1024 sc1
    buffer_load_dwordx4 v[236:239], v241, s[40:43], s87 offen offset:1024 sc1
    s_waitcnt vmcnt(0)
    v_add3_u32 v26, v224, v225, v226
    v_add3_u32 v27, v227, v228, v229
    v_add3_u32 v26, v26, v230, v231
    v_add3_u32 v27, v27, v232, v233
    v_add3_u32 v26, v26, v234, v235
    v_add3_u32 v27, v27, v236, v237
    v_add3_u32 v26, v26, v238, v239
    v_add_u32 v26, v26, v27
    s_nop 1
    v_add_u32_dpp v26, v26, v26 row_ror:8 row_mask:0xf bank_mask:0xf
    s_nop 1
    v_add_u32_dpp v26, v26, v26 row_ror:4 row_mask:0xf bank_mask:0xf
    s_nop 1
    v_add_u32_dpp v26, v26, v26 row_ror:2 row_mask:0xf bank_mask:0xf
    v_add_u32 v26, v26, v112
    s_nop 1
    v_add_u32_dpp v26, v26, v26 quad_perm:[1,0,3,2] row_mask:0xf bank_mask:0xf
    v_cmp_ne_u32 vcc, s76, v26
    s_and_b64 vcc, vcc, s[66:67]
    s_cbranch_vccz L_ok7
    s_sub_u32 s59, s59, 1
    s_cbranch_scc0 L_rt7_l
    s_branch L_ok7
.section .rodata,"a"
.p2align 6
.amdhsa_kernel standalone__linear_kernel_hedgehog__prompt_kernel
  .amdhsa_next_free_vgpr 256
  .amdhsa_next_free_sgpr 102
  .amdhsa_accum_offset 256
  .amdhsa_group_segment_fixed_size 0
  .amdhsa_kernarg_size 56
  .amdhsa_user_sgpr_count 2
  .amdhsa_user_sgpr_kernarg_segment_ptr 1
  .amdhsa_system_sgpr_workgroup_id_x 1
.end_amdhsa_kernel
```
